```python
import torch

def _softmax(x, axis=-1):
    return torch.softmax(x, dim=axis)
def _gelu(x):
    return torch.nn.functional.gelu(x, approximate="tanh")
def _silu(x):
    return torch.nn.functional.silu(x)
def _sigmoid(x):
    return torch.sigmoid(x)
def _layernorm(x, axis=-1, eps=1e-5):
    m = x.mean(dim=axis, keepdim=True)
    v = x.var(dim=axis, keepdim=True, unbiased=False)
    return (x - m) / torch.sqrt(v + eps)
def _scatter_add(tgt, idx, src, axis=0):
    return tgt.clone().index_add_(axis, idx, src)
def _segment_sum(src, seg, n):
    out = torch.zeros((n,) + src.shape[1:], dtype=src.dtype)
    return out.index_add_(0, seg, src)
def _pad(x, pw):
    flat = tuple(v for pair in reversed(pw) for v in pair)
    return torch.nn.functional.pad(x, flat)

kernel_name = 'recurrent_scan__sliding_local_dilated__dense_activation_mish__prompt'

def setup_inputs():

    _w = (lambda a: (lambda t: t.to(torch.bfloat16) if t.is_floating_point() else t)(torch.as_tensor(a)))
    def _A_setup():
        B, S, D = 1, 2048, 448
        return {
            "x": _w((lambda *s: torch.randn(*s, dtype=torch.bfloat16) * 0.05)(B, S, D)),
            "wqkv": _w((lambda *s: torch.randn(*s, dtype=torch.bfloat16) * 0.2)(D, 3 * D)),
            "wo": _w((lambda *s: torch.randn(*s, dtype=torch.bfloat16) * 0.2)(D, D)),
        }
    _A_in = _A_setup()

    def _B_setup():
        B, S, D, F = 1, 2048, 448, 1792
        return {
            "x": _w((lambda *s: torch.randn(*s, dtype=torch.bfloat16) * 0.05)(B, S, D)),
            "w1": _w((lambda *s: torch.randn(*s, dtype=torch.bfloat16) * 0.8)(D, F) * (D ** -0.5)),
            "b1": _w((lambda *s: torch.randn(*s, dtype=torch.bfloat16) * 0.4)(F)),
            "w2": _w((lambda *s: torch.randn(*s, dtype=torch.bfloat16) * 0.1)(F, D) * (F ** -0.5)),
        }
    _B_in = _B_setup()

    return {
        "A_x": _A_in["x"],
        "A_wqkv": _A_in["wqkv"],
        "A_wo": _A_in["wo"],
        "B_x": _B_in["x"],
        "B_w1": _B_in["w1"],
        "B_b1": _B_in["b1"],
        "B_w2": _B_in["w2"],
    }

def reference(A_x, A_wqkv, A_wo, B_x, B_w1, B_b1, B_w2):
    def _A_ref(x, wqkv, wo):
        B, S, D = x.shape
        H = 16; Dh = D // H
        W, dil = 8, 2
        qkv = (lambda x, *d: x.permute(*d))((x @ wqkv).reshape(B, S, 3, H, Dh), 2, 0, 3, 1, 4)
        q, k, v = qkv[0], qkv[1], qkv[2]
        scale = Dh ** -0.5
        pos = torch.arange(S)
        off = torch.arange(W) * dil
        idx = pos[:, None] - off[None, :]
        mask = idx >= 0
        idx_c = torch.where(mask, idx, 0).reshape(-1)
        kg = k[:, :, idx_c, :].reshape(B, H, S, W, Dh)
        vg = v[:, :, idx_c, :].reshape(B, H, S, W, Dh)
        logits = torch.einsum("bhsd,bhswd->bhsw", q, kg) * scale
        logits = torch.where(mask[None, None, :, :], logits, -1e9)
        attn = _softmax(logits, axis=-1)
        o = torch.einsum("bhsw,bhswd->bhsd", attn, vg)
        return (lambda x, *d: x.permute(*d))(o, 0, 2, 1, 3).reshape(B, S, D) @ wo

    def _B_ref(x, w1, b1, w2):
        h = torch.einsum("bsd,df->bsf", x, w1) + b1
        sp = torch.log1p(torch.exp(-torch.abs(h))) + torch.where(h > 0, h, torch.zeros_like(h))
        act = h * torch.tanh(sp)
        return torch.einsum("bsf,fd->bsd", act, w2)

    x = A_x
    xn = _layernorm(x, axis=-1)
    s = _A_ref(xn, A_wqkv, A_wo)
    g = _silu(_B_ref(xn, B_w1, B_b1, B_w2))
    return x + s * g
```

```asm
; @launch grid=(256,1,1) block=(512,1,1) lds=163840
.amdgcn_target "amdgcn-amd-amdhsa--gfx950"
.text
.globl recurrent_scan__sliding_local_dilated__dense_activation_mish__prompt_kernel
.p2align 8
.type recurrent_scan__sliding_local_dilated__dense_activation_mish__prompt_kernel,@function
recurrent_scan__sliding_local_dilated__dense_activation_mish__prompt_kernel:
    s_cmp_ge_u32 s2, 256
    s_cbranch_scc1 K1_END
    s_load_dwordx4 s[4:7], s[0:1], 0
    s_load_dwordx2 s[8:9], s[0:1], 16
    s_load_dwordx4 s[12:15], s[0:1], 32
    s_load_dwordx2 s[10:11], s[0:1], 48
    s_load_dwordx2 s[16:17], s[0:1], 72
    s_getpc_b64 s[80:81]
K1_PC:
    v_cmp_gt_u32 vcc, 9, v0
    s_cbranch_vccz K1_NOPF
    s_sub_u32 s80, s80, K1_PC-recurrent_scan__sliding_local_dilated__dense_activation_mish__prompt_kernel
    s_subb_u32 s81, s81, 0
    s_mov_b32 s82, CODE_END-recurrent_scan__sliding_local_dilated__dense_activation_mish__prompt_kernel
    s_mov_b32 s83, 0x20000
    s_lshr_b32 s84, s2, 3
    s_mul_i32 s84, s84, 1152
    v_lshlrev_b32 v2, 7, v0
    s_mov_b64 exec, vcc
    buffer_load_dword v255, v2, s[80:83], s84 offen
    s_mov_b64 exec, -1
K1_NOPF:
    v_lshrrev_b32 v1, 6, v0
    v_and_b32 v0, 63, v0
    v_readfirstlane_b32 s3, v1
    s_bfe_u32 s49, s2, 0x10002
    s_bfe_u32 s44, s2, 0x30003
    s_lshl3_add_u32 s44, s49, s44
    s_and_b32 s49, s2, 3
    s_bfe_u32 s45, s2, 0x10006
    s_lshl1_add_u32 s45, s49, s45
    s_mov_b32 s22, 1835008
    s_mov_b32 s23, 0x20000
    s_mov_b32 s27, 0x20000
    s_cmp_ge_u32 s2, 128
    s_cbranch_scc0 ATT
FFN:
    s_and_b32 s56, s45, 1
    s_mul_i32 s57, s45, 7
    s_lshr_b32 s57, s57, 1
    s_lshl_b32 s52, s44, 7
    s_lshl_b32 s49, s3, 4
    s_add_u32 s52, s52, s49
    s_mul_i32 s52, s52, 896
    s_lshl_b32 s53, s3, 11
    s_lshl_b32 s55, s3, 10
    s_add_u32 s49, s57, s56
    s_lshl_b32 s49, s49, 7
    s_mul_i32 s54, s3, 28672
    s_add_u32 s54, s54, s49
    v_lshrrev_b32 v244, 4, v0
    s_and_b32 s49, s3, 1
    s_lshl_b32 s49, s49, 2
    v_add_u32 v244, s49, v244
    v_and_b32 v245, 7, v0
    v_xor_b32 v244, v244, v245
    v_lshrrev_b32 v245, 3, v0
    v_mul_u32_u24 v245, 896, v245
    v_lshl_add_u32 v1, v244, 4, v245
    v_bfe_u32 v244, v0, 4, 1
    v_lshlrev_b32 v244, 2, v244
    v_and_b32 v245, 7, v0
    v_xor_b32 v244, v244, v245
    v_lshlrev_b32 v244, 4, v244
    v_lshrrev_b32 v245, 3, v0
    v_mul_u32_u24 v245, 3584, v245
    v_add_u32 v2, v244, v245
    s_mov_b32 s26, 1605632
    s_waitcnt lgkmcnt(0)
    s_mov_b32 s20, s4
    s_mov_b32 s21, s5
    s_mov_b32 s24, s12
    s_mov_b32 s25, s13
    s_add_u32 m0, s53, 57344
    s_add_u32 s49, s52, 0
    buffer_load_dwordx4 v1, s[20:23], s49 offen lds
    s_add_u32 m0, s53, 58368
    s_add_u32 s49, s52, 7168
    buffer_load_dwordx4 v1, s[20:23], s49 offen lds
    s_add_u32 m0, s55, 0
    s_add_u32 s49, s54, 0
    buffer_load_dwordx4 v2, s[24:27], s49 offen lds
    s_barrier
    s_add_u32 m0, s53, 73728
    s_add_u32 s49, s52, 128
    buffer_load_dwordx4 v1, s[20:23], s49 offen lds
    s_add_u32 m0, s53, 74752
    s_add_u32 s49, s52, 7296
    buffer_load_dwordx4 v1, s[20:23], s49 offen lds
    s_add_u32 m0, s55, 8192
    s_add_u32 s49, s54, 229376
    buffer_load_dwordx4 v2, s[24:27], s49 offen lds
    s_barrier
    s_add_u32 m0, s53, 90112
    s_add_u32 s49, s52, 256
    buffer_load_dwordx4 v1, s[20:23], s49 offen lds
    s_add_u32 m0, s53, 91136
    s_add_u32 s49, s52, 7424
    buffer_load_dwordx4 v1, s[20:23], s49 offen lds
    s_add_u32 m0, s55, 16384
    s_add_u32 s49, s54, 458752
    buffer_load_dwordx4 v2, s[24:27], s49 offen lds
    s_add_u32 s100, s16, 9439232
    s_addc_u32 s101, s17, 0
    s_load_dword s78, s[100:101], 0
    s_load_dwordx2 s[18:19], s[0:1], 56
    s_and_b32 s46, s3, 3
    s_lshr_b32 s47, s3, 2
    s_xor_b32 s48, s46, s47
    s_and_b32 s51, s2, 0xfffffff8
    s_add_u32 s51, s51, s3
    s_xor_b32 s47, s47, s56
    s_xor_b32 s48, s46, s47
    v_lshlrev_b32 v12, 4, v0
    v_and_b32 v244, 15, v0
    v_lshlrev_b32 v244, 1, v244
    v_bfe_u32 v245, v0, 4, 1
    v_add_u32 v244, v244, v245
    s_lshl_b32 s49, s46, 5
    v_add_u32 v244, s49, v244
    v_lshlrev_b32 v244, 7, v244
    v_and_b32 v245, 3, v0
    v_bfe_u32 v246, v0, 3, 1
    v_lshl_add_u32 v245, v246, 2, v245
    v_lshrrev_b32 v246, 5, v0
    s_lshl_b32 s49, s48, 1
    v_add_u32 v246, s49, v246
    v_xor_b32 v245, v245, v246
    v_lshl_add_u32 v244, v245, 4, v244
    v_add_u32 v4, 57344, v244
    v_xor_b32 v5, 32, v4
    v_xor_b32 v6, 64, v4
    v_xor_b32 v7, 96, v4
    s_lshl_b32 s50, s47, 6
    v_lshrrev_b32 v244, 5, v0
    v_lshlrev_b32 v244, 3, v244
    v_bfe_u32 v245, v0, 2, 2
    v_add_u32 v244, v244, v245
    v_lshlrev_b32 v244, 7, v244
    v_bfe_u32 v245, v0, 4, 1
    v_lshlrev_b32 v245, 5, v245
    v_and_b32 v249, 3, v0
    v_lshl_add_u32 v245, v249, 3, v245
    v_add_u32 v245, s50, v245
    v_bfe_u32 v249, v0, 3, 1
    v_lshlrev_b32 v249, 6, v249
    v_xor_b32 v245, v245, v249
    v_add_u32 v249, v244, v245
    s_xor_b32 s49, s48, 0
    s_lshl_b32 s49, s49, 11
    v_add_u32 v8, s49, v249
    s_xor_b32 s49, s48, 1
    s_lshl_b32 s49, s49, 11
    v_add_u32 v9, s49, v249
    s_xor_b32 s49, s48, 2
    s_lshl_b32 s49, s49, 11
    v_add_u32 v10, s49, v249
    s_xor_b32 s49, s48, 3
    s_lshl_b32 s49, s49, 11
    v_add_u32 v11, s49, v249
    v_mov_b32 v32, 0x3f803f80
    v_mov_b32 v30, 0
    v_mov_b32 v31, 0
    v_mov_b32 v25, 0
    v_mov_b32 v119, 0
    v_mov_b32 v123, 0
    v_mov_b32 v127, 0
    v_and_b32 v244, 3, v0
    v_bfe_u32 v245, v0, 2, 1
    v_bfe_u32 v36, v0, 4, 1
    v_xor_b32 v245, v245, v36
    v_or_b32 v244, v244, v245
    v_cmp_eq_u32 vcc, 0, v244
    v_mov_b32 v245, 0x3f803f80
    s_nop 0
    v_cndmask_b32 v36, 0, v245, vcc
    v_mov_b32 v37, v36
    v_mov_b32 v38, v36
    v_mov_b32 v39, v36
    v_and_b32 v244, 31, v0
    v_lshlrev_b32 v247, 1, v244
    v_lshlrev_b32 v244, 5, v244
    s_lshl_b32 s49, s47, 10
    s_add_u32 s49, s49, 155648
    v_add_u32 v34, s49, v244
    v_lshrrev_b32 v245, 5, v0
    v_lshlrev_b32 v246, 2, v245
    v_add_u32 v246, s46, v246
    v_lshl_add_u32 v33, v246, 2, v34
    s_lshl_b32 s49, s46, 10
    s_add_u32 s49, s49, 157696
    v_add_u32 v35, s49, v244
    s_lshl_b32 s49, s47, 1
    v_add_u32 v245, s49, v245
    v_lshl_add_u32 v3, v245, 3, v35
    s_lshr_b32 s50, s3, 2
    s_cmp_lt_u32 s51, 196
    s_cselect_b32 s32, s10, s8
    s_cselect_b32 s33, s11, s9
    s_mov_b32 s34, 401408
    s_cselect_b32 s34, 1605632, s34
    s_mov_b32 s35, 0x20000
    s_cselect_b32 s77, 0, 196
    s_sub_u32 s77, s51, s77
    s_lshl_b32 s77, s77, 13
    s_mov_b32 s79, 1073741824
    s_cmp_eq_u32 s50, 0
    s_cselect_b32 s49, s79, s77
    s_cselect_b32 s77, s77, s79
    s_mov_b32 s79, s49
    s_mov_b32 s28, s16
    s_mov_b32 s29, s17
    s_mov_b32 s30, 9441280
    s_mov_b32 s31, 0x20000
    s_mov_b32 s40, s14
    s_mov_b32 s41, s15
    s_mov_b32 s42, 3584
    s_mov_b32 s43, 0x20000
    s_lshl_b32 s50, s44, 2
    s_add_u32 s50, s50, s46
    s_mul_i32 s64, s50, 144
    s_add_u32 s64, s64, 32
    s_lshl_b32 s50, s47, 1
    s_add_u32 s64, s64, s50
    s_add_u32 s49, s56, 0
    s_and_b32 s49, s49, 3
    s_add_u32 s49, s49, s57
    s_lshl_b32 s65, s49, 2
    s_add_u32 s65, s65, s64
    s_lshl_b32 s60, s65, 10
    s_lshl_b32 s49, s49, 7
    s_lshl_b32 s50, s47, 6
    s_add_u32 s49, s49, s50
    buffer_load_ushort v24, v247, s[40:43], s49 offen
    s_add_u32 s49, s56, 1
    s_and_b32 s49, s49, 3
    s_add_u32 s49, s49, s57
    s_lshl_b32 s65, s49, 2
    s_add_u32 s65, s65, s64
    s_lshl_b32 s61, s65, 10
    s_lshl_b32 s49, s49, 7
    s_lshl_b32 s50, s47, 6
    s_add_u32 s49, s49, s50
    buffer_load_ushort v118, v247, s[40:43], s49 offen
    s_add_u32 s49, s56, 2
    s_and_b32 s49, s49, 3
    s_add_u32 s49, s49, s57
    s_lshl_b32 s65, s49, 2
    s_add_u32 s65, s65, s64
    s_lshl_b32 s62, s65, 10
    s_lshl_b32 s49, s49, 7
    s_lshl_b32 s50, s47, 6
    s_add_u32 s49, s49, s50
    buffer_load_ushort v122, v247, s[40:43], s49 offen
    s_add_u32 s49, s56, 3
    s_and_b32 s49, s49, 3
    s_add_u32 s49, s49, s57
    s_lshl_b32 s65, s49, 2
    s_add_u32 s65, s65, s64
    s_lshl_b32 s63, s65, 10
    s_lshl_b32 s49, s49, 7
    s_lshl_b32 s50, s47, 6
    s_add_u32 s49, s49, s50
    buffer_load_ushort v126, v247, s[40:43], s49 offen
    s_mov_b32 s70, -1
    s_mov_b32 s71, 0
    s_add_u32 s49, s56, 1
    s_and_b32 s49, s49, 3
    s_sub_u32 s49, s49, s56
    s_lshl_b32 s49, s49, 7
    s_add_u32 s65, s54, s49
    s_add_u32 s49, s56, 2
    s_and_b32 s49, s49, 3
    s_sub_u32 s49, s49, s56
    s_lshl_b32 s49, s49, 7
    s_add_u32 s66, s54, s49
    s_add_u32 s49, s56, 3
    s_and_b32 s49, s49, 3
    s_sub_u32 s49, s49, s56
    s_lshl_b32 s49, s49, 7
    s_add_u32 s67, s54, s49
    s_cmp_eq_u32 s47, s56
    s_cselect_b32 s58, 1, 0
    s_lshr_b32 s49, s2, 3
    s_mul_i32 s97, s49, 37
    s_lshr_b32 s97, s97, 8
    s_mul_i32 s50, s97, 7
    s_sub_u32 s98, s49, s50
    s_and_b32 s49, s2, 7
    s_lshl_b32 s49, s49, 2
    s_add_u32 s97, s97, s49
    s_mov_b32 s91, s3
    s_sub_u32 s49, s91, 2
    s_mul_i32 s99, s49, 19
    s_cmp_eq_u32 s91, 7
    s_cselect_b32 s99, 94, s99
    s_mul_i32 s49, s91, 200704
    s_mul_i32 s50, s99, 14336
    s_cmp_lt_u32 s91, 2
    s_cselect_b32 s90, s49, s50
    s_cselect_b32 s92, s8, s10
    s_cselect_b32 s93, s9, s11
    s_mov_b32 s94, 1605632
    s_cselect_b32 s94, 401408, s94
    s_mov_b32 s95, 0x20000
    s_mov_b32 s96, 14336
    s_cselect_b32 s96, 10752, s96
    s_mov_b32 s49, 6144
    s_cselect_b32 s49, 2560, s49
    s_cselect_b32 s50, 1073741824, 0
    s_cselect_b64 vcc, -1, 0
    v_lshrrev_b32 v244, 3, v0
    v_and_b32 v245, 7, v0
    v_bfe_u32 v246, v0, 4, 1
    v_lshlrev_b32 v246, 2, v246
    v_xor_b32 v246, v246, v245
    v_lshrrev_b32 v247, 2, v244
    v_and_b32 v248, 3, v244
    v_lshl_add_u32 v248, v247, 3, v248
    v_cndmask_b32 v244, v244, v248, vcc
    v_mul_u32_u24 v244, 896, v244
    v_lshl_add_u32 v252, v246, 4, v244
    v_add_u32 v253, s49, v252
    v_mul_lo_u32 v247, v247, s50
    v_add_u32 v254, v253, v247
    s_lshl_b32 s49, s98, 7
    s_add_u32 s90, s90, s49
    s_lshl_b32 s91, s91, 11
    s_waitcnt vmcnt(10)
    s_waitcnt lgkmcnt(0)
    s_barrier
    ds_read_b128 v[128:131], v4 offset:0
    ds_read_b64_tr_b16 v[72:73], v8 offset:0
    ds_read_b64_tr_b16 v[74:75], v8 offset:512
    ds_read_b128 v[132:135], v5 offset:0
    ds_read_b64_tr_b16 v[76:77], v9 offset:0
    ds_read_b64_tr_b16 v[78:79], v9 offset:512
    ds_read_b128 v[136:139], v6 offset:0
    ds_read_b64_tr_b16 v[80:81], v10 offset:0
    ds_read_b64_tr_b16 v[82:83], v10 offset:512
    ds_read_b128 v[140:143], v7 offset:0
    ds_read_b64_tr_b16 v[84:85], v11 offset:0
    ds_read_b64_tr_b16 v[86:87], v11 offset:512
    s_add_u32 m0, s53, 106496
    s_add_u32 s49, s52, 384
    buffer_load_dwordx4 v1, s[20:23], s49 offen lds
    s_add_u32 m0, s53, 107520
    s_add_u32 s49, s52, 7552
    buffer_load_dwordx4 v1, s[20:23], s49 offen lds
    s_add_u32 m0, s55, 24576
    s_add_u32 s49, s54, 688128
    buffer_load_dwordx4 v2, s[24:27], s49 offen lds
    s_cmp_lt_u32 s3, 4
    s_cbranch_scc1 FFN_T3W
    s_and_b32 s68, s44, 7
    s_lshl_b32 s68, s68, 2
    s_add_u32 s68, s68, s3
    s_sub_u32 s68, s68, 4
    s_mul_i32 s68, s68, 50176
    s_lshl_b32 s69, s57, 7
    s_add_u32 s68, s68, s69
    v_lshrrev_b32 v250, 2, v0
    v_mul_u32_u24 v250, 3584, v250
    v_and_b32 v249, 3, v0
    v_lshl_add_u32 v250, v249, 7, v250
    buffer_load_dword v251, v250, s[24:27], s68 offen
FFN_T3W:
    s_waitcnt vmcnt(10)
    s_waitcnt lgkmcnt(0)
    s_barrier
    v_mfma_f32_32x32x16_bf16 v[56:71], v[72:75], v[128:131], 0
    ds_read_b128 v[144:147], v4 offset:16384
    ds_read_b64_tr_b16 v[40:41], v8 offset:8192
    ds_read_b64_tr_b16 v[42:43], v8 offset:8704
    s_add_u32 m0, s53, 122880
    s_add_u32 s49, s52, 512
    buffer_load_dwordx4 v1, s[20:23], s49 offen lds
    v_mfma_f32_16x16x32_bf16 v[26:29], v[36:39], v[72:75], 0
    v_mfma_f32_32x32x16_bf16 v[56:71], v[76:79], v[132:135], v[56:71]
    ds_read_b128 v[148:151], v5 offset:16384
    ds_read_b64_tr_b16 v[44:45], v9 offset:8192
    ds_read_b64_tr_b16 v[46:47], v9 offset:8704
    s_add_u32 m0, s53, 123904
    s_add_u32 s49, s52, 7680
    buffer_load_dwordx4 v1, s[20:23], s49 offen lds
    v_mfma_f32_32x32x16_bf16 v[56:71], v[80:83], v[136:139], v[56:71]
    ds_read_b128 v[152:155], v6 offset:16384
    ds_read_b64_tr_b16 v[48:49], v10 offset:8192
    ds_read_b64_tr_b16 v[50:51], v10 offset:8704
    s_add_u32 m0, s55, 32768
    s_add_u32 s49, s54, 917504
    buffer_load_dwordx4 v2, s[24:27], s49 offen lds
    v_mfma_f32_32x32x16_bf16 v[56:71], v[84:87], v[140:143], v[56:71]
    ds_read_b128 v[156:159], v7 offset:16384
    ds_read_b64_tr_b16 v[52:53], v11 offset:8192
    ds_read_b64_tr_b16 v[54:55], v11 offset:8704
    v_dot2_f32_bf16 v30, v128, v32, v30
    v_dot2_f32_bf16 v31, v128, v128, v31
    v_dot2_f32_bf16 v30, v129, v32, v30
    v_dot2_f32_bf16 v31, v129, v129, v31
    v_dot2_f32_bf16 v30, v130, v32, v30
    v_dot2_f32_bf16 v31, v130, v130, v31
    v_dot2_f32_bf16 v30, v131, v32, v30
    v_dot2_f32_bf16 v31, v131, v131, v31
    v_dot2_f32_bf16 v30, v136, v32, v30
    v_dot2_f32_bf16 v31, v136, v136, v31
    v_dot2_f32_bf16 v30, v137, v32, v30
    v_dot2_f32_bf16 v31, v137, v137, v31
    v_dot2_f32_bf16 v30, v138, v32, v30
    v_dot2_f32_bf16 v31, v138, v138, v31
    v_dot2_f32_bf16 v30, v139, v32, v30
    v_dot2_f32_bf16 v31, v139, v139, v31
    s_waitcnt vmcnt(10)
    s_waitcnt lgkmcnt(0)
    s_barrier
    v_mfma_f32_32x32x16_bf16 v[56:71], v[40:43], v[144:147], v[56:71]
    ds_read_b128 v[160:163], v4 offset:32768
    ds_read_b64_tr_b16 v[72:73], v8 offset:16384
    ds_read_b64_tr_b16 v[74:75], v8 offset:16896
    s_add_u32 m0, s53, 139264
    s_add_u32 s49, s52, 640
    buffer_load_dwordx4 v1, s[20:23], s49 offen lds
    v_mfma_f32_16x16x32_bf16 v[26:29], v[36:39], v[40:43], v[26:29]
    v_mfma_f32_32x32x16_bf16 v[56:71], v[44:47], v[148:151], v[56:71]
    ds_read_b128 v[164:167], v5 offset:32768
    ds_read_b64_tr_b16 v[76:77], v9 offset:16384
    ds_read_b64_tr_b16 v[78:79], v9 offset:16896
    s_add_u32 m0, s53, 140288
    s_add_u32 s49, s52, 7808
    buffer_load_dwordx4 v1, s[20:23], s49 offen lds
    v_mfma_f32_32x32x16_bf16 v[56:71], v[48:51], v[152:155], v[56:71]
    ds_read_b128 v[168:171], v6 offset:32768
    ds_read_b64_tr_b16 v[80:81], v10 offset:16384
    ds_read_b64_tr_b16 v[82:83], v10 offset:16896
    s_add_u32 m0, s55, 40960
    s_add_u32 s49, s54, 1146880
    buffer_load_dwordx4 v2, s[24:27], s49 offen lds
    v_mfma_f32_32x32x16_bf16 v[56:71], v[52:55], v[156:159], v[56:71]
    ds_read_b128 v[172:175], v7 offset:32768
    ds_read_b64_tr_b16 v[84:85], v11 offset:16384
    ds_read_b64_tr_b16 v[86:87], v11 offset:16896
    v_dot2_f32_bf16 v30, v144, v32, v30
    v_dot2_f32_bf16 v31, v144, v144, v31
    v_dot2_f32_bf16 v30, v145, v32, v30
    v_dot2_f32_bf16 v31, v145, v145, v31
    v_dot2_f32_bf16 v30, v146, v32, v30
    v_dot2_f32_bf16 v31, v146, v146, v31
    v_dot2_f32_bf16 v30, v147, v32, v30
    v_dot2_f32_bf16 v31, v147, v147, v31
    v_dot2_f32_bf16 v30, v152, v32, v30
    v_dot2_f32_bf16 v31, v152, v152, v31
    v_dot2_f32_bf16 v30, v153, v32, v30
    v_dot2_f32_bf16 v31, v153, v153, v31
    v_dot2_f32_bf16 v30, v154, v32, v30
    v_dot2_f32_bf16 v31, v154, v154, v31
    v_dot2_f32_bf16 v30, v155, v32, v30
    v_dot2_f32_bf16 v31, v155, v155, v31
    s_waitcnt vmcnt(6)
    s_waitcnt lgkmcnt(0)
    s_barrier
    v_mfma_f32_32x32x16_bf16 v[56:71], v[72:75], v[160:163], v[56:71]
    ds_read_b128 v[176:179], v4 offset:49152
    ds_read_b64_tr_b16 v[40:41], v8 offset:24576
    ds_read_b64_tr_b16 v[42:43], v8 offset:25088
    s_add_u32 m0, s53, 0
    s_add_u32 s49, s52, 768
    buffer_load_dwordx4 v1, s[20:23], s49 offen lds
    v_mfma_f32_16x16x32_bf16 v[26:29], v[36:39], v[72:75], v[26:29]
    v_mfma_f32_32x32x16_bf16 v[56:71], v[76:79], v[164:167], v[56:71]
    ds_read_b128 v[180:183], v5 offset:49152
    ds_read_b64_tr_b16 v[44:45], v9 offset:24576
    ds_read_b64_tr_b16 v[46:47], v9 offset:25088
    s_add_u32 m0, s53, 1024
    s_add_u32 s49, s52, 7936
    buffer_load_dwordx4 v1, s[20:23], s49 offen lds
    v_mfma_f32_32x32x16_bf16 v[56:71], v[80:83], v[168:171], v[56:71]
    ds_read_b128 v[184:187], v6 offset:49152
    ds_read_b64_tr_b16 v[48:49], v10 offset:24576
    ds_read_b64_tr_b16 v[50:51], v10 offset:25088
    s_add_u32 m0, s55, 49152
    s_add_u32 s49, s54, 1376256
    buffer_load_dwordx4 v2, s[24:27], s49 offen lds
    v_mfma_f32_32x32x16_bf16 v[56:71], v[84:87], v[172:175], v[56:71]
    ds_read_b128 v[188:191], v7 offset:49152
    ds_read_b64_tr_b16 v[52:53], v11 offset:24576
    ds_read_b64_tr_b16 v[54:55], v11 offset:25088
    v_dot2_f32_bf16 v30, v160, v32, v30
    v_dot2_f32_bf16 v31, v160, v160, v31
    v_dot2_f32_bf16 v30, v161, v32, v30
    v_dot2_f32_bf16 v31, v161, v161, v31
    v_dot2_f32_bf16 v30, v162, v32, v30
    v_dot2_f32_bf16 v31, v162, v162, v31
    v_dot2_f32_bf16 v30, v163, v32, v30
    v_dot2_f32_bf16 v31, v163, v163, v31
    v_dot2_f32_bf16 v30, v168, v32, v30
    v_dot2_f32_bf16 v31, v168, v168, v31
    v_dot2_f32_bf16 v30, v169, v32, v30
    v_dot2_f32_bf16 v31, v169, v169, v31
    v_dot2_f32_bf16 v30, v170, v32, v30
    v_dot2_f32_bf16 v31, v170, v170, v31
    v_dot2_f32_bf16 v30, v171, v32, v30
    v_dot2_f32_bf16 v31, v171, v171, v31
    s_waitcnt vmcnt(6)
    s_waitcnt lgkmcnt(0)
    s_barrier
    v_lshl_or_b32 v24, v24, 16, v24
    v_lshl_or_b32 v118, v118, 16, v118
    v_lshl_or_b32 v122, v122, 16, v122
    v_lshl_or_b32 v126, v126, 16, v126
    v_add_u32 v4, 0x10000, v4
    v_add_u32 v5, 0x10000, v5
    v_add_u32 v6, 0x10000, v6
    v_add_u32 v7, 0x10000, v7
    v_mfma_f32_32x32x16_bf16 v[56:71], v[40:43], v[176:179], v[56:71]
    ds_read_b128 v[192:195], v4 offset:0
    ds_read_b64_tr_b16 v[72:73], v8 offset:32768
    ds_read_b64_tr_b16 v[74:75], v8 offset:33280
    s_add_u32 m0, s55, 57344
    s_add_u32 s49, s65, 0
    buffer_load_dwordx4 v2, s[24:27], s49 offen lds
    v_mfma_f32_16x16x32_bf16 v[26:29], v[36:39], v[40:43], v[26:29]
    v_mfma_f32_32x32x16_bf16 v[56:71], v[44:47], v[180:183], v[56:71]
    ds_read_b128 v[196:199], v5 offset:0
    ds_read_b64_tr_b16 v[76:77], v9 offset:32768
    ds_read_b64_tr_b16 v[78:79], v9 offset:33280
    s_add_u32 m0, s55, 65536
    s_add_u32 s49, s65, 229376
    buffer_load_dwordx4 v2, s[24:27], s49 offen lds
    v_mfma_f32_32x32x16_bf16 v[56:71], v[48:51], v[184:187], v[56:71]
    ds_read_b128 v[200:203], v6 offset:0
    ds_read_b64_tr_b16 v[80:81], v10 offset:32768
    ds_read_b64_tr_b16 v[82:83], v10 offset:33280
    s_add_u32 m0, s55, 73728
    s_add_u32 s49, s65, 458752
    buffer_load_dwordx4 v2, s[24:27], s49 offen lds
    v_mfma_f32_32x32x16_bf16 v[56:71], v[52:55], v[188:191], v[56:71]
    ds_read_b128 v[204:207], v7 offset:0
    ds_read_b64_tr_b16 v[84:85], v11 offset:32768
    ds_read_b64_tr_b16 v[86:87], v11 offset:33280
    v_dot2_f32_bf16 v30, v176, v32, v30
    v_dot2_f32_bf16 v31, v176, v176, v31
    v_dot2_f32_bf16 v30, v177, v32, v30
    v_dot2_f32_bf16 v31, v177, v177, v31
    v_dot2_f32_bf16 v30, v178, v32, v30
    v_dot2_f32_bf16 v31, v178, v178, v31
    v_dot2_f32_bf16 v30, v179, v32, v30
    v_dot2_f32_bf16 v31, v179, v179, v31
    v_dot2_f32_bf16 v30, v184, v32, v30
    v_dot2_f32_bf16 v31, v184, v184, v31
    v_dot2_f32_bf16 v30, v185, v32, v30
    v_dot2_f32_bf16 v31, v185, v185, v31
    v_dot2_f32_bf16 v30, v186, v32, v30
    v_dot2_f32_bf16 v31, v186, v186, v31
    v_dot2_f32_bf16 v30, v187, v32, v30
    v_dot2_f32_bf16 v31, v187, v187, v31
    s_waitcnt vmcnt(6)
    s_waitcnt lgkmcnt(0)
    s_barrier
    v_mfma_f32_32x32x16_bf16 v[56:71], v[72:75], v[192:195], v[56:71]
    ds_read_b128 v[208:211], v4 offset:16384
    ds_read_b64_tr_b16 v[40:41], v8 offset:40960
    ds_read_b64_tr_b16 v[42:43], v8 offset:41472
    s_add_u32 m0, s55, 81920
    s_add_u32 s49, s65, 688128
    buffer_load_dwordx4 v2, s[24:27], s49 offen lds
    v_mfma_f32_16x16x32_bf16 v[26:29], v[36:39], v[72:75], v[26:29]
    v_mfma_f32_32x32x16_bf16 v[56:71], v[76:79], v[196:199], v[56:71]
    ds_read_b128 v[212:215], v5 offset:16384
    ds_read_b64_tr_b16 v[44:45], v9 offset:40960
    ds_read_b64_tr_b16 v[46:47], v9 offset:41472
    s_add_u32 m0, s55, 90112
    s_add_u32 s49, s65, 917504
    buffer_load_dwordx4 v2, s[24:27], s49 offen lds
    v_mfma_f32_32x32x16_bf16 v[56:71], v[80:83], v[200:203], v[56:71]
    ds_read_b128 v[216:219], v6 offset:16384
    ds_read_b64_tr_b16 v[48:49], v10 offset:40960
    ds_read_b64_tr_b16 v[50:51], v10 offset:41472
    s_add_u32 m0, s55, 98304
    s_add_u32 s49, s65, 1146880
    buffer_load_dwordx4 v2, s[24:27], s49 offen lds
    v_mfma_f32_32x32x16_bf16 v[56:71], v[84:87], v[204:207], v[56:71]
    ds_read_b128 v[220:223], v7 offset:16384
    ds_read_b64_tr_b16 v[52:53], v11 offset:40960
    ds_read_b64_tr_b16 v[54:55], v11 offset:41472
    s_add_u32 m0, s55, 106496
    s_add_u32 s49, s65, 1376256
    buffer_load_dwordx4 v2, s[24:27], s49 offen lds
    v_dot2_f32_bf16 v30, v192, v32, v30
    v_dot2_f32_bf16 v31, v192, v192, v31
    v_dot2_f32_bf16 v30, v193, v32, v30
    v_dot2_f32_bf16 v31, v193, v193, v31
    v_dot2_f32_bf16 v30, v194, v32, v30
    v_dot2_f32_bf16 v31, v194, v194, v31
    v_dot2_f32_bf16 v30, v195, v32, v30
    v_dot2_f32_bf16 v31, v195, v195, v31
    v_dot2_f32_bf16 v30, v200, v32, v30
    v_dot2_f32_bf16 v31, v200, v200, v31
    v_dot2_f32_bf16 v30, v201, v32, v30
    v_dot2_f32_bf16 v31, v201, v201, v31
    v_dot2_f32_bf16 v30, v202, v32, v30
    v_dot2_f32_bf16 v31, v202, v202, v31
    v_dot2_f32_bf16 v30, v203, v32, v30
    v_dot2_f32_bf16 v31, v203, v203, v31
    s_waitcnt vmcnt(7)
    s_waitcnt lgkmcnt(0)
    s_barrier
    v_subrev_u32 v4, 122880, v4
    v_subrev_u32 v5, 122880, v5
    v_subrev_u32 v6, 122880, v6
    v_subrev_u32 v7, 122880, v7
    v_mfma_f32_32x32x16_bf16 v[56:71], v[40:43], v[208:211], v[56:71]
    ds_read_b128 v[224:227], v4 offset:0
    ds_read_b64_tr_b16 v[72:73], v8 offset:49152
    ds_read_b64_tr_b16 v[74:75], v8 offset:49664
    v_mfma_f32_16x16x32_bf16 v[26:29], v[36:39], v[40:43], v[26:29]
    v_mfma_f32_32x32x16_bf16 v[56:71], v[44:47], v[212:215], v[56:71]
    ds_read_b128 v[228:231], v5 offset:0
    ds_read_b64_tr_b16 v[76:77], v9 offset:49152
    ds_read_b64_tr_b16 v[78:79], v9 offset:49664
    v_mfma_f32_32x32x16_bf16 v[56:71], v[48:51], v[216:219], v[56:71]
    ds_read_b128 v[232:235], v6 offset:0
    ds_read_b64_tr_b16 v[80:81], v10 offset:49152
    ds_read_b64_tr_b16 v[82:83], v10 offset:49664
    v_mfma_f32_32x32x16_bf16 v[56:71], v[52:55], v[220:223], v[56:71]
    ds_read_b128 v[236:239], v7 offset:0
    ds_read_b64_tr_b16 v[84:85], v11 offset:49152
    ds_read_b64_tr_b16 v[86:87], v11 offset:49664
    v_dot2_f32_bf16 v30, v208, v32, v30
    v_dot2_f32_bf16 v31, v208, v208, v31
    v_dot2_f32_bf16 v30, v209, v32, v30
    v_dot2_f32_bf16 v31, v209, v209, v31
    v_dot2_f32_bf16 v30, v210, v32, v30
    v_dot2_f32_bf16 v31, v210, v210, v31
    v_dot2_f32_bf16 v30, v211, v32, v30
    v_dot2_f32_bf16 v31, v211, v211, v31
    v_dot2_f32_bf16 v30, v216, v32, v30
    v_dot2_f32_bf16 v31, v216, v216, v31
    v_dot2_f32_bf16 v30, v217, v32, v30
    v_dot2_f32_bf16 v31, v217, v217, v31
    v_dot2_f32_bf16 v30, v218, v32, v30
    v_dot2_f32_bf16 v31, v218, v218, v31
    v_dot2_f32_bf16 v30, v219, v32, v30
    v_dot2_f32_bf16 v31, v219, v219, v31
    s_waitcnt lgkmcnt(0)
    v_mfma_f32_16x16x32_bf16 v[26:29], v[36:39], v[72:75], v[26:29]
    v_dot2_f32_bf16 v30, v224, v32, v30
    v_dot2_f32_bf16 v31, v224, v224, v31
    v_dot2_f32_bf16 v30, v225, v32, v30
    v_dot2_f32_bf16 v31, v225, v225, v31
    v_dot2_f32_bf16 v30, v226, v32, v30
    v_dot2_f32_bf16 v31, v226, v226, v31
    v_dot2_f32_bf16 v30, v227, v32, v30
    v_dot2_f32_bf16 v31, v227, v227, v31
    v_dot2_f32_bf16 v30, v232, v32, v30
    v_dot2_f32_bf16 v31, v232, v232, v31
    v_dot2_f32_bf16 v30, v233, v32, v30
    v_dot2_f32_bf16 v31, v233, v233, v31
    v_dot2_f32_bf16 v30, v234, v32, v30
    v_dot2_f32_bf16 v31, v234, v234, v31
    v_dot2_f32_bf16 v30, v235, v32, v30
    v_dot2_f32_bf16 v31, v235, v235, v31
    s_nop 2
    ds_write_b64 v3, v[30:31]
    ds_write_b32 v33, v26
    v_add_u32 v8, 57344, v8
    v_add_u32 v9, 57344, v9
    v_add_u32 v10, 57344, v10
    v_add_u32 v11, 57344, v11
    v_xor_b32 v33, 0x1800, v33
    s_waitcnt vmcnt(0)
    s_waitcnt lgkmcnt(0)
    s_barrier
    ds_read_b128 v[88:91], v35
    ds_read_b128 v[92:95], v35 offset:16
    ds_read_b128 v[112:115], v34
    v_xor_b32 v34, 0x1800, v34
    ds_read_b64_tr_b16 v[40:41], v8 offset:0
    ds_read_b64_tr_b16 v[42:43], v8 offset:512
    ds_read_b64_tr_b16 v[44:45], v8 offset:8192
    ds_read_b64_tr_b16 v[46:47], v8 offset:8704
    ds_read_b64_tr_b16 v[48:49], v8 offset:16384
    ds_read_b64_tr_b16 v[50:51], v8 offset:16896
    v_mfma_f32_32x32x16_bf16 v[56:71], v[72:75], v[224:227], v[56:71]
    v_mov_b32 v21, 0
    v_mfma_f32_32x32x16_bf16 v[56:71], v[76:79], v[228:231], v[56:71]
    s_waitcnt lgkmcnt(7)
    v_add_f32 v88, v88, v90
    v_add_f32 v89, v89, v91
    v_add_f32 v92, v92, v94
    v_add_f32 v93, v93, v95
    s_waitcnt lgkmcnt(6)
    v_mfma_f32_32x32x16_bf16 v[56:71], v[80:83], v[232:235], v[56:71]
    v_add_f32 v88, v88, v92
    v_add_f32 v89, v89, v93
    v_mul_f32 v96, 0xbb124925, v88
    v_mul_f32 v97, 0x3b124925, v89
    v_mfma_f32_32x32x16_bf16 v[56:71], v[84:87], v[236:239], v[56:71]
    v_cvt_pk_bf16_f32 v99, v96, v96
    v_fma_f32 v98, -v96, v96, v97
    v_and_b32 v100, 0xffff0000, v99
    v_max_f32 v98, 0, v98
    s_cmp_eq_u32 s47, 0
    s_cbranch_scc1 FFN_PR1
    s_setprio 1
FFN_PR1:
    ds_read_b64_tr_b16 v[52:53], v8 offset:24576
    ds_read_b64_tr_b16 v[54:55], v8 offset:25088
    s_waitcnt lgkmcnt(6)
    v_mfma_f32_16x16x32_bf16 v[26:29], v[36:39], v[40:43], 0
    v_mfma_f32_32x32x16_bf16 v[72:87], v[40:43], v[128:131], 0
    s_add_u32 m0, s55, 0
    s_add_u32 s49, s66, 0
    buffer_load_dwordx4 v2, s[24:27], s49 offen lds
    v_sub_f32 v96, v96, v100
    v_add_f32 v98, 0x3727c5ac, v98
    v_cndmask_b32 v18, 0, v99, s[70:71]
    v_cvt_pk_bf16_f32 v99, v96, v96
    ds_read_b64_tr_b16 v[40:41], v8 offset:32768
    ds_read_b64_tr_b16 v[42:43], v8 offset:33280
    s_waitcnt lgkmcnt(6)
    v_mfma_f32_16x16x32_bf16 v[26:29], v[36:39], v[44:47], v[26:29]
    v_mfma_f32_32x32x16_bf16 v[72:87], v[44:47], v[144:147], v[72:87]
    v_rsq_f32 v97, v98
    v_cndmask_b32 v19, 0, v99, s[70:71]
    v_add_f32 v112, v112, v113
    v_add_f32 v114, v114, v115
    v_add_f32 v112, v112, v114
    v_cvt_pk_bf16_f32 v113, v112, v112
    ds_read_b64_tr_b16 v[44:45], v8 offset:40960
    ds_read_b64_tr_b16 v[46:47], v8 offset:41472
    s_waitcnt lgkmcnt(6)
    v_mfma_f32_16x16x32_bf16 v[26:29], v[36:39], v[48:51], v[26:29]
    v_mfma_f32_32x32x16_bf16 v[72:87], v[48:51], v[160:163], v[72:87]
    s_add_u32 m0, s55, 8192
    s_add_u32 s49, s66, 229376
    buffer_load_dwordx4 v2, s[24:27], s49 offen lds
    v_mul_f32 v98, v98, v97
    v_cvt_pk_bf16_f32 v99, v98, v98
    v_and_b32 v100, 0xffff0000, v99
    v_sub_f32 v100, v98, v100
    ds_read_b64_tr_b16 v[48:49], v8 offset:49152
    ds_read_b64_tr_b16 v[50:51], v8 offset:49664
    s_waitcnt lgkmcnt(6)
    v_mfma_f32_16x16x32_bf16 v[26:29], v[36:39], v[52:55], v[26:29]
    v_mfma_f32_32x32x16_bf16 v[72:87], v[52:55], v[176:179], v[72:87]
    v_cvt_pk_bf16_f32 v99, v98, v100
    v_cndmask_b32 v20, 0, v99, s[70:71]
    v_mul_f32 v13, 0x3fb8aa3b, v97
    v_and_b32 v114, 0xffff0000, v113
    v_sub_f32 v114, v112, v114
    v_cvt_pk_bf16_f32 v22, v112, v114
    ds_read_b64_tr_b16 v[52:53], v9 offset:0
    ds_read_b64_tr_b16 v[54:55], v9 offset:512
    s_waitcnt lgkmcnt(6)
    v_mfma_f32_16x16x32_bf16 v[26:29], v[36:39], v[40:43], v[26:29]
    v_mfma_f32_32x32x16_bf16 v[72:87], v[40:43], v[192:195], v[72:87]
    s_add_u32 m0, s55, 16384
    s_add_u32 s49, s66, 458752
    buffer_load_dwordx4 v2, s[24:27], s49 offen lds
    v_cvt_pk_bf16_f32 v23, v112, v114
    s_nop 1
    v_mfma_f32_32x32x16_bf16 v[56:71], v[22:25], v[18:21], v[56:71]
    ds_read_b64_tr_b16 v[40:41], v10 offset:0
    ds_read_b64_tr_b16 v[42:43], v10 offset:512
    s_waitcnt lgkmcnt(6)
    v_mfma_f32_16x16x32_bf16 v[26:29], v[36:39], v[44:47], v[26:29]
    v_mfma_f32_32x32x16_bf16 v[72:87], v[44:47], v[208:211], v[72:87]
    ds_read_b64_tr_b16 v[44:45], v11 offset:0
    ds_read_b64_tr_b16 v[46:47], v11 offset:512
    s_waitcnt lgkmcnt(6)
    v_mfma_f32_16x16x32_bf16 v[26:29], v[36:39], v[48:51], v[26:29]
    v_mfma_f32_32x32x16_bf16 v[72:87], v[48:51], v[224:227], v[72:87]
    s_add_u32 m0, s55, 24576
    s_add_u32 s49, s66, 688128
    buffer_load_dwordx4 v2, s[24:27], s49 offen lds
    v_mul_f32 v56, v13, v56
    v_mul_f32 v57, v13, v57
    v_mul_f32 v58, v13, v58
    v_mul_f32 v59, v13, v59
    ds_read_b64_tr_b16 v[48:49], v9 offset:8192
    ds_read_b64_tr_b16 v[50:51], v9 offset:8704
    s_waitcnt lgkmcnt(6)
    v_mfma_f32_32x32x16_bf16 v[72:87], v[52:55], v[132:135], v[72:87]
    v_exp_f32 v88, v56
    v_exp_f32 v89, v57
    ds_read_b64_tr_b16 v[52:53], v10 offset:8192
    ds_read_b64_tr_b16 v[54:55], v10 offset:8704
    s_waitcnt lgkmcnt(6)
    v_mfma_f32_32x32x16_bf16 v[72:87], v[40:43], v[136:139], v[72:87]
    s_add_u32 m0, s55, 32768
    s_add_u32 s49, s66, 917504
    buffer_load_dwordx4 v2, s[24:27], s49 offen lds
    v_exp_f32 v90, v58
    v_exp_f32 v91, v59
    ds_read_b64_tr_b16 v[40:41], v11 offset:8192
    ds_read_b64_tr_b16 v[42:43], v11 offset:8704
    s_waitcnt lgkmcnt(6)
    v_mfma_f32_32x32x16_bf16 v[72:87], v[44:47], v[140:143], v[72:87]
    v_fma_f32 v96, v88, 0.5, 1.0
    v_fma_f32 v97, v89, 0.5, 1.0
    v_fma_f32 v96, v88, v96, 1.0
    ds_write_b32 v33, v26
    v_xor_b32 v33, 0x1800, v33
    ds_read_b64_tr_b16 v[44:45], v9 offset:16384
    ds_read_b64_tr_b16 v[46:47], v9 offset:16896
    s_waitcnt lgkmcnt(7)
    v_mfma_f32_32x32x16_bf16 v[72:87], v[48:51], v[148:151], v[72:87]
    s_add_u32 m0, s55, 40960
    s_add_u32 s49, s66, 1146880
    buffer_load_dwordx4 v2, s[24:27], s49 offen lds
    v_rcp_f32 v96, v96
    v_fma_f32 v97, v89, v97, 1.0
    ds_read_b64_tr_b16 v[48:49], v10 offset:16384
    ds_read_b64_tr_b16 v[50:51], v10 offset:16896
    s_waitcnt lgkmcnt(7)
    v_mfma_f32_32x32x16_bf16 v[72:87], v[52:55], v[152:155], v[72:87]
    v_rcp_f32 v97, v97
    v_fma_f32 v56, -v56, v96, v56
    v_fma_f32 v98, v90, 0.5, 1.0
    v_fma_f32 v99, v91, 0.5, 1.0
    ds_read_b64_tr_b16 v[52:53], v11 offset:16384
    ds_read_b64_tr_b16 v[54:55], v11 offset:16896
    s_waitcnt lgkmcnt(7)
    v_mfma_f32_32x32x16_bf16 v[72:87], v[40:43], v[156:159], v[72:87]
    s_add_u32 m0, s55, 49152
    s_add_u32 s49, s66, 1376256
    buffer_load_dwordx4 v2, s[24:27], s49 offen lds
    v_fma_f32 v57, -v57, v97, v57
    v_cvt_pk_bf16_f32 v104, v56, v57
    ds_read_b64_tr_b16 v[40:41], v9 offset:24576
    ds_read_b64_tr_b16 v[42:43], v9 offset:25088
    s_waitcnt lgkmcnt(6)
    v_mfma_f32_32x32x16_bf16 v[72:87], v[44:47], v[164:167], v[72:87]
    v_lshlrev_b32 v250, 7, v0
    buffer_load_dword v251, v250, s[32:35], s77 offen
    v_fma_f32 v98, v90, v98, 1.0
    v_fma_f32 v99, v91, v99, 1.0
    ds_read_b64_tr_b16 v[44:45], v10 offset:24576
    ds_read_b64_tr_b16 v[46:47], v10 offset:25088
    s_waitcnt lgkmcnt(6)
    v_mfma_f32_32x32x16_bf16 v[72:87], v[48:51], v[168:171], v[72:87]
    v_rcp_f32 v98, v98
    v_rcp_f32 v99, v99
    v_mul_f32 v60, v13, v60
    v_mul_f32 v61, v13, v61
    ds_read_b64_tr_b16 v[48:49], v11 offset:24576
    ds_read_b64_tr_b16 v[50:51], v11 offset:25088
    s_waitcnt lgkmcnt(6)
    v_mfma_f32_32x32x16_bf16 v[72:87], v[52:55], v[172:175], v[72:87]
    v_exp_f32 v92, v60
    v_exp_f32 v93, v61
    v_fma_f32 v58, -v58, v98, v58
    v_fma_f32 v59, -v59, v99, v59
    s_cmp_eq_u32 s47, 0
    s_cbranch_scc1 FFN_PR2
    s_setprio 0
FFN_PR2:
    ds_read_b64_tr_b16 v[52:53], v9 offset:32768
    ds_read_b64_tr_b16 v[54:55], v9 offset:33280
    s_waitcnt lgkmcnt(6)
    v_mfma_f32_32x32x16_bf16 v[72:87], v[40:43], v[180:183], v[72:87]
    v_cvt_pk_bf16_f32 v105, v58, v59
    v_fma_f32 v100, v92, 0.5, 1.0
    v_fma_f32 v101, v93, 0.5, 1.0
    v_fma_f32 v100, v92, v100, 1.0
    ds_read_b64_tr_b16 v[40:41], v10 offset:32768
    ds_read_b64_tr_b16 v[42:43], v10 offset:33280
    s_waitcnt lgkmcnt(6)
    v_mfma_f32_32x32x16_bf16 v[72:87], v[44:47], v[184:187], v[72:87]
    v_rcp_f32 v100, v100
    v_fma_f32 v101, v93, v101, 1.0
    v_mul_f32 v62, v13, v62
    v_mul_f32 v63, v13, v63
    ds_read_b64_tr_b16 v[44:45], v11 offset:32768
    ds_read_b64_tr_b16 v[46:47], v11 offset:33280
    s_waitcnt lgkmcnt(6)
    v_mfma_f32_32x32x16_bf16 v[72:87], v[48:51], v[188:191], v[72:87]
    v_rcp_f32 v101, v101
    v_exp_f32 v94, v62
    v_fma_f32 v60, -v60, v100, v60
    v_mul_f32 v64, v13, v64
    ds_read_b64_tr_b16 v[48:49], v9 offset:40960
    ds_read_b64_tr_b16 v[50:51], v9 offset:41472
    s_waitcnt lgkmcnt(6)
    v_mfma_f32_32x32x16_bf16 v[72:87], v[52:55], v[196:199], v[72:87]
    v_exp_f32 v95, v63
    v_exp_f32 v88, v64
    v_fma_f32 v61, -v61, v101, v61
    v_cvt_pk_bf16_f32 v106, v60, v61
    ds_read_b64_tr_b16 v[52:53], v10 offset:40960
    ds_read_b64_tr_b16 v[54:55], v10 offset:41472
    s_waitcnt lgkmcnt(6)
    v_mfma_f32_32x32x16_bf16 v[72:87], v[40:43], v[200:203], v[72:87]
    v_fma_f32 v102, v94, 0.5, 1.0
    v_fma_f32 v103, v95, 0.5, 1.0
    v_fma_f32 v102, v94, v102, 1.0
    v_fma_f32 v103, v95, v103, 1.0
    ds_read_b64_tr_b16 v[40:41], v11 offset:40960
    ds_read_b64_tr_b16 v[42:43], v11 offset:41472
    s_waitcnt lgkmcnt(6)
    v_mfma_f32_32x32x16_bf16 v[72:87], v[44:47], v[204:207], v[72:87]
    v_rcp_f32 v102, v102
    v_rcp_f32 v103, v103
    v_mul_f32 v65, v13, v65
    v_fma_f32 v96, v88, 0.5, 1.0
    ds_read_b64_tr_b16 v[44:45], v9 offset:49152
    ds_read_b64_tr_b16 v[46:47], v9 offset:49664
    s_waitcnt lgkmcnt(6)
    v_mfma_f32_32x32x16_bf16 v[72:87], v[48:51], v[212:215], v[72:87]
    v_exp_f32 v89, v65
    v_fma_f32 v62, -v62, v102, v62
    v_fma_f32 v63, -v63, v103, v63
    v_cvt_pk_bf16_f32 v107, v62, v63
    ds_read_b64_tr_b16 v[48:49], v10 offset:49152
    ds_read_b64_tr_b16 v[50:51], v10 offset:49664
    s_waitcnt lgkmcnt(6)
    v_mfma_f32_32x32x16_bf16 v[72:87], v[52:55], v[216:219], v[72:87]
    buffer_store_dwordx4 v[104:107], v12, s[28:31], s60 offen offset:0 sc1
    v_fma_f32 v97, v89, 0.5, 1.0
    v_fma_f32 v96, v88, v96, 1.0
    v_fma_f32 v97, v89, v97, 1.0
    ds_read_b64_tr_b16 v[52:53], v11 offset:49152
    ds_read_b64_tr_b16 v[54:55], v11 offset:49664
    s_waitcnt lgkmcnt(6)
    v_mfma_f32_32x32x16_bf16 v[72:87], v[40:43], v[220:223], v[72:87]
    v_rcp_f32 v96, v96
    v_rcp_f32 v97, v97
    v_mul_f32 v66, v13, v66
    v_mul_f32 v67, v13, v67
    s_waitcnt lgkmcnt(0)
    s_waitcnt vmcnt(2)
    s_barrier
    v_add_u32 v8, 0xffff2000, v8
    v_add_u32 v9, 0xffff2000, v9
    v_add_u32 v10, 0xffff2000, v10
    v_add_u32 v11, 0xffff2000, v11
    ds_read_b128 v[112:115], v34
    v_xor_b32 v34, 0x1800, v34
    ds_read_b64_tr_b16 v[40:41], v8 offset:0
    ds_read_b64_tr_b16 v[42:43], v8 offset:512
    v_mfma_f32_32x32x16_bf16 v[72:87], v[44:47], v[228:231], v[72:87]
    s_add_u32 m0, s55, 57344
    s_add_u32 s49, s67, 0
    buffer_load_dwordx4 v2, s[24:27], s49 offen lds
    v_exp_f32 v90, v66
    v_exp_f32 v91, v67
    ds_read_b64_tr_b16 v[44:45], v8 offset:8192
    ds_read_b64_tr_b16 v[46:47], v8 offset:8704
    v_mfma_f32_32x32x16_bf16 v[72:87], v[48:51], v[232:235], v[72:87]
    v_fma_f32 v64, -v64, v96, v64
    v_fma_f32 v65, -v65, v97, v65
    v_cvt_pk_bf16_f32 v108, v64, v65
    v_fma_f32 v98, v90, 0.5, 1.0
    ds_read_b64_tr_b16 v[48:49], v8 offset:16384
    ds_read_b64_tr_b16 v[50:51], v8 offset:16896
    v_mfma_f32_32x32x16_bf16 v[72:87], v[52:55], v[236:239], v[72:87]
    s_add_u32 m0, s55, 65536
    s_add_u32 s49, s67, 229376
    buffer_load_dwordx4 v2, s[24:27], s49 offen lds
    v_fma_f32 v99, v91, 0.5, 1.0
    v_fma_f32 v98, v90, v98, 1.0
    v_rcp_f32 v98, v98
    v_fma_f32 v99, v91, v99, 1.0
    v_mul_f32 v68, v13, v68
    v_mul_f32 v69, v13, v69
    v_mul_f32 v70, v13, v70
    v_mul_f32 v71, v13, v71
    v_rcp_f32 v99, v99
    v_exp_f32 v92, v68
    v_fma_f32 v66, -v66, v98, v66
    v_exp_f32 v93, v69
    v_exp_f32 v94, v70
    v_fma_f32 v67, -v67, v99, v67
    v_cvt_pk_bf16_f32 v109, v66, v67
    v_fma_f32 v100, v92, 0.5, 1.0
    v_fma_f32 v100, v92, v100, 1.0
    v_rcp_f32 v100, v100
    v_exp_f32 v95, v71
    v_fma_f32 v101, v93, 0.5, 1.0
    v_fma_f32 v101, v93, v101, 1.0
    v_fma_f32 v102, v94, 0.5, 1.0
    v_fma_f32 v102, v94, v102, 1.0
    v_rcp_f32 v101, v101
    v_rcp_f32 v102, v102
    v_fma_f32 v68, -v68, v100, v68
    v_fma_f32 v103, v95, 0.5, 1.0
    v_fma_f32 v103, v95, v103, 1.0
    v_rcp_f32 v103, v103
    v_fma_f32 v69, -v69, v101, v69
    v_cvt_pk_bf16_f32 v110, v68, v69
    v_fma_f32 v70, -v70, v102, v70
    v_fma_f32 v71, -v71, v103, v71
    v_cvt_pk_bf16_f32 v111, v70, v71
    buffer_store_dwordx4 v[108:111], v12, s[28:31], s60 offen offset:1024 sc1
    s_cmp_eq_u32 s47, 0
    s_cbranch_scc1 FFN_PR3
    s_setprio 1
FFN_PR3:
    ds_read_b64_tr_b16 v[52:53], v8 offset:24576
    ds_read_b64_tr_b16 v[54:55], v8 offset:25088
    s_waitcnt lgkmcnt(6)
    v_mfma_f32_16x16x32_bf16 v[26:29], v[36:39], v[40:43], 0
    v_mfma_f32_32x32x16_bf16 v[56:71], v[40:43], v[128:131], 0
    v_add_f32 v112, v112, v113
    v_add_f32 v114, v114, v115
    v_add_f32 v112, v112, v114
    v_cvt_pk_bf16_f32 v113, v112, v112
    v_and_b32 v114, 0xffff0000, v113
    v_sub_f32 v114, v112, v114
    ds_read_b64_tr_b16 v[40:41], v8 offset:32768
    ds_read_b64_tr_b16 v[42:43], v8 offset:33280
    s_waitcnt lgkmcnt(6)
    v_mfma_f32_16x16x32_bf16 v[26:29], v[36:39], v[44:47], v[26:29]
    v_mfma_f32_32x32x16_bf16 v[56:71], v[44:47], v[144:147], v[56:71]
    s_add_u32 m0, s55, 73728
    s_add_u32 s49, s67, 458752
    buffer_load_dwordx4 v2, s[24:27], s49 offen lds
    v_cvt_pk_bf16_f32 v116, v112, v114
    v_cvt_pk_bf16_f32 v117, v112, v114
    s_nop 1
    v_mfma_f32_32x32x16_bf16 v[72:87], v[116:119], v[18:21], v[72:87]
    ds_read_b64_tr_b16 v[44:45], v8 offset:40960
    ds_read_b64_tr_b16 v[46:47], v8 offset:41472
    s_waitcnt lgkmcnt(6)
    v_mfma_f32_16x16x32_bf16 v[26:29], v[36:39], v[48:51], v[26:29]
    v_mfma_f32_32x32x16_bf16 v[56:71], v[48:51], v[160:163], v[56:71]
    ds_read_b64_tr_b16 v[48:49], v8 offset:49152
    ds_read_b64_tr_b16 v[50:51], v8 offset:49664
    s_waitcnt lgkmcnt(6)
    v_mfma_f32_16x16x32_bf16 v[26:29], v[36:39], v[52:55], v[26:29]
    v_mfma_f32_32x32x16_bf16 v[56:71], v[52:55], v[176:179], v[56:71]
    s_add_u32 m0, s55, 81920
    s_add_u32 s49, s67, 688128
    buffer_load_dwordx4 v2, s[24:27], s49 offen lds
    v_mul_f32 v72, v13, v72
    v_mul_f32 v73, v13, v73
    v_mul_f32 v74, v13, v74
    ds_read_b64_tr_b16 v[52:53], v9 offset:0
    ds_read_b64_tr_b16 v[54:55], v9 offset:512
    s_waitcnt lgkmcnt(6)
    v_mfma_f32_16x16x32_bf16 v[26:29], v[36:39], v[40:43], v[26:29]
    v_mfma_f32_32x32x16_bf16 v[56:71], v[40:43], v[192:195], v[56:71]
    v_exp_f32 v88, v72
    v_exp_f32 v89, v73
    v_mul_f32 v75, v13, v75
    v_mul_f32 v76, v13, v76
    ds_read_b64_tr_b16 v[40:41], v10 offset:0
    ds_read_b64_tr_b16 v[42:43], v10 offset:512
    s_waitcnt lgkmcnt(6)
    v_mfma_f32_16x16x32_bf16 v[26:29], v[36:39], v[44:47], v[26:29]
    v_mfma_f32_32x32x16_bf16 v[56:71], v[44:47], v[208:211], v[56:71]
    s_add_u32 m0, s55, 90112
    s_add_u32 s49, s67, 917504
    buffer_load_dwordx4 v2, s[24:27], s49 offen lds
    v_exp_f32 v90, v74
    v_exp_f32 v91, v75
    v_fma_f32 v96, v88, 0.5, 1.0
    v_fma_f32 v97, v89, 0.5, 1.0
    ds_read_b64_tr_b16 v[44:45], v11 offset:0
    ds_read_b64_tr_b16 v[46:47], v11 offset:512
    s_waitcnt lgkmcnt(6)
    v_mfma_f32_16x16x32_bf16 v[26:29], v[36:39], v[48:51], v[26:29]
    v_mfma_f32_32x32x16_bf16 v[56:71], v[48:51], v[224:227], v[56:71]
    v_exp_f32 v92, v76
    v_fma_f32 v96, v88, v96, 1.0
    v_fma_f32 v97, v89, v97, 1.0
    v_fma_f32 v98, v90, 0.5, 1.0
    v_fma_f32 v99, v91, 0.5, 1.0
    v_fma_f32 v98, v90, v98, 1.0
    ds_read_b64_tr_b16 v[48:49], v9 offset:8192
    ds_read_b64_tr_b16 v[50:51], v9 offset:8704
    s_waitcnt lgkmcnt(6)
    v_mfma_f32_32x32x16_bf16 v[56:71], v[52:55], v[132:135], v[56:71]
    s_add_u32 m0, s55, 98304
    s_add_u32 s49, s67, 1146880
    buffer_load_dwordx4 v2, s[24:27], s49 offen lds
    v_rcp_f32 v96, v96
    v_rcp_f32 v97, v97
    ds_read_b64_tr_b16 v[52:53], v10 offset:8192
    ds_read_b64_tr_b16 v[54:55], v10 offset:8704
    s_waitcnt lgkmcnt(6)
    v_mfma_f32_32x32x16_bf16 v[56:71], v[40:43], v[136:139], v[56:71]
    v_rcp_f32 v98, v98
    v_fma_f32 v72, -v72, v96, v72
    v_fma_f32 v73, -v73, v97, v73
    v_cvt_pk_bf16_f32 v104, v72, v73
    ds_read_b64_tr_b16 v[40:41], v11 offset:8192
    ds_read_b64_tr_b16 v[42:43], v11 offset:8704
    s_waitcnt lgkmcnt(6)
    v_mfma_f32_32x32x16_bf16 v[56:71], v[44:47], v[140:143], v[56:71]
    s_add_u32 m0, s55, 106496
    s_add_u32 s49, s67, 1376256
    buffer_load_dwordx4 v2, s[24:27], s49 offen lds
    v_fma_f32 v99, v91, v99, 1.0
    ds_write_b32 v33, v26
    v_xor_b32 v33, 0x1800, v33
    ds_read_b64_tr_b16 v[44:45], v9 offset:16384
    ds_read_b64_tr_b16 v[46:47], v9 offset:16896
    s_waitcnt lgkmcnt(7)
    v_mfma_f32_32x32x16_bf16 v[56:71], v[48:51], v[148:151], v[56:71]
    v_rcp_f32 v99, v99
    v_fma_f32 v74, -v74, v98, v74
    v_mul_f32 v77, v13, v77
    v_fma_f32 v100, v92, 0.5, 1.0
    ds_read_b64_tr_b16 v[48:49], v10 offset:16384
    ds_read_b64_tr_b16 v[50:51], v10 offset:16896
    s_waitcnt lgkmcnt(7)
    v_mfma_f32_32x32x16_bf16 v[56:71], v[52:55], v[152:155], v[56:71]
    v_lshlrev_b32 v250, 7, v0
    buffer_load_dword v251, v250, s[32:35], s79 offen
    v_exp_f32 v93, v77
    v_fma_f32 v75, -v75, v99, v75
    ds_read_b64_tr_b16 v[52:53], v11 offset:16384
    ds_read_b64_tr_b16 v[54:55], v11 offset:16896
    s_waitcnt lgkmcnt(7)
    v_mfma_f32_32x32x16_bf16 v[56:71], v[40:43], v[156:159], v[56:71]
    v_cvt_pk_bf16_f32 v105, v74, v75
    v_fma_f32 v101, v93, 0.5, 1.0
    v_fma_f32 v100, v92, v100, 1.0
    v_fma_f32 v101, v93, v101, 1.0
    ds_read_b64_tr_b16 v[40:41], v9 offset:24576
    ds_read_b64_tr_b16 v[42:43], v9 offset:25088
    s_waitcnt lgkmcnt(6)
    v_mfma_f32_32x32x16_bf16 v[56:71], v[44:47], v[164:167], v[56:71]
    v_rcp_f32 v100, v100
    v_rcp_f32 v101, v101
    v_mul_f32 v78, v13, v78
    v_mul_f32 v79, v13, v79
    ds_read_b64_tr_b16 v[44:45], v10 offset:24576
    ds_read_b64_tr_b16 v[46:47], v10 offset:25088
    s_waitcnt lgkmcnt(6)
    v_mfma_f32_32x32x16_bf16 v[56:71], v[48:51], v[168:171], v[56:71]
    v_exp_f32 v94, v78
    v_exp_f32 v95, v79
    v_fma_f32 v76, -v76, v100, v76
    v_fma_f32 v77, -v77, v101, v77
    ds_read_b64_tr_b16 v[48:49], v11 offset:24576
    ds_read_b64_tr_b16 v[50:51], v11 offset:25088
    s_waitcnt lgkmcnt(6)
    v_mfma_f32_32x32x16_bf16 v[56:71], v[52:55], v[172:175], v[56:71]
    v_cvt_pk_bf16_f32 v106, v76, v77
    v_fma_f32 v102, v94, 0.5, 1.0
    v_fma_f32 v103, v95, 0.5, 1.0
    v_fma_f32 v102, v94, v102, 1.0
    s_cmp_eq_u32 s47, 0
    s_cbranch_scc1 FFN_PR4
    s_setprio 0
FFN_PR4:
    ds_read_b64_tr_b16 v[52:53], v9 offset:32768
    ds_read_b64_tr_b16 v[54:55], v9 offset:33280
    s_waitcnt lgkmcnt(6)
    v_mfma_f32_32x32x16_bf16 v[56:71], v[40:43], v[180:183], v[56:71]
    v_rcp_f32 v102, v102
    v_fma_f32 v103, v95, v103, 1.0
    v_mul_f32 v80, v13, v80
    v_mul_f32 v81, v13, v81
    ds_read_b64_tr_b16 v[40:41], v10 offset:32768
    ds_read_b64_tr_b16 v[42:43], v10 offset:33280
    s_waitcnt lgkmcnt(6)
    v_mfma_f32_32x32x16_bf16 v[56:71], v[44:47], v[184:187], v[56:71]
    v_rcp_f32 v103, v103
    v_exp_f32 v88, v80
    v_fma_f32 v78, -v78, v102, v78
    ds_read_b64_tr_b16 v[44:45], v11 offset:32768
    ds_read_b64_tr_b16 v[46:47], v11 offset:33280
    s_waitcnt lgkmcnt(6)
    v_mfma_f32_32x32x16_bf16 v[56:71], v[48:51], v[188:191], v[56:71]
    v_exp_f32 v89, v81
    v_fma_f32 v79, -v79, v103, v79
    v_cvt_pk_bf16_f32 v107, v78, v79
    buffer_store_dwordx4 v[104:107], v12, s[28:31], s61 offen offset:0 sc1
    ds_read_b64_tr_b16 v[48:49], v9 offset:40960
    ds_read_b64_tr_b16 v[50:51], v9 offset:41472
    s_waitcnt lgkmcnt(6)
    v_mfma_f32_32x32x16_bf16 v[56:71], v[52:55], v[196:199], v[56:71]
    v_fma_f32 v96, v88, 0.5, 1.0
    v_fma_f32 v97, v89, 0.5, 1.0
    v_fma_f32 v96, v88, v96, 1.0
    v_fma_f32 v97, v89, v97, 1.0
    ds_read_b64_tr_b16 v[52:53], v10 offset:40960
    ds_read_b64_tr_b16 v[54:55], v10 offset:41472
    s_waitcnt lgkmcnt(6)
    v_mfma_f32_32x32x16_bf16 v[56:71], v[40:43], v[200:203], v[56:71]
    v_rcp_f32 v96, v96
    v_rcp_f32 v97, v97
    v_mul_f32 v82, v13, v82
    v_mul_f32 v83, v13, v83
    ds_read_b64_tr_b16 v[40:41], v11 offset:40960
    ds_read_b64_tr_b16 v[42:43], v11 offset:41472
    s_waitcnt lgkmcnt(6)
    v_mfma_f32_32x32x16_bf16 v[56:71], v[44:47], v[204:207], v[56:71]
    v_exp_f32 v90, v82
    v_exp_f32 v91, v83
    v_fma_f32 v80, -v80, v96, v80
    v_fma_f32 v81, -v81, v97, v81
    ds_read_b64_tr_b16 v[44:45], v9 offset:49152
    ds_read_b64_tr_b16 v[46:47], v9 offset:49664
    s_waitcnt lgkmcnt(6)
    v_mfma_f32_32x32x16_bf16 v[56:71], v[48:51], v[212:215], v[56:71]
    v_cvt_pk_bf16_f32 v108, v80, v81
    v_fma_f32 v98, v90, 0.5, 1.0
    v_fma_f32 v99, v91, 0.5, 1.0
    v_fma_f32 v98, v90, v98, 1.0
    ds_read_b64_tr_b16 v[48:49], v10 offset:49152
    ds_read_b64_tr_b16 v[50:51], v10 offset:49664
    s_waitcnt lgkmcnt(6)
    v_mfma_f32_32x32x16_bf16 v[56:71], v[52:55], v[216:219], v[56:71]
    v_rcp_f32 v98, v98
    v_fma_f32 v99, v91, v99, 1.0
    v_mul_f32 v84, v13, v84
    v_mul_f32 v85, v13, v85
    ds_read_b64_tr_b16 v[52:53], v11 offset:49152
    ds_read_b64_tr_b16 v[54:55], v11 offset:49664
    s_waitcnt lgkmcnt(6)
    v_mfma_f32_32x32x16_bf16 v[56:71], v[40:43], v[220:223], v[56:71]
    v_rcp_f32 v99, v99
    v_exp_f32 v92, v84
    v_fma_f32 v82, -v82, v98, v82
    v_mul_f32 v86, v13, v86
    s_waitcnt lgkmcnt(0)
    s_waitcnt vmcnt(2)
    s_barrier
    s_cmp_eq_u32 s58, 0
    s_cbranch_scc1 FFN_IDLE
    v_add_u32 v8, 0xe000, v8
    v_add_u32 v9, 0xe000, v9
    v_add_u32 v10, 0xe000, v10
    v_add_u32 v11, 0xe000, v11
    ds_read_b128 v[112:115], v34
    v_xor_b32 v34, 0x1800, v34
    ds_read_b64_tr_b16 v[40:41], v8 offset:0
    ds_read_b64_tr_b16 v[42:43], v8 offset:512
    v_mfma_f32_32x32x16_bf16 v[56:71], v[44:47], v[228:231], v[56:71]
    v_exp_f32 v93, v85
    v_exp_f32 v94, v86
    v_fma_f32 v83, -v83, v99, v83
    v_cvt_pk_bf16_f32 v109, v82, v83
    ds_read_b64_tr_b16 v[44:45], v8 offset:8192
    ds_read_b64_tr_b16 v[46:47], v8 offset:8704
    v_mfma_f32_32x32x16_bf16 v[56:71], v[48:51], v[232:235], v[56:71]
    v_fma_f32 v100, v92, 0.5, 1.0
    v_fma_f32 v101, v93, 0.5, 1.0
    v_fma_f32 v100, v92, v100, 1.0
    v_fma_f32 v101, v93, v101, 1.0
    ds_read_b64_tr_b16 v[48:49], v8 offset:16384
    ds_read_b64_tr_b16 v[50:51], v8 offset:16896
    v_mfma_f32_32x32x16_bf16 v[56:71], v[52:55], v[236:239], v[56:71]
    v_rcp_f32 v100, v100
    v_rcp_f32 v101, v101
    v_mul_f32 v87, v13, v87
    v_fma_f32 v102, v94, 0.5, 1.0
    v_exp_f32 v95, v87
    v_fma_f32 v84, -v84, v100, v84
    v_fma_f32 v85, -v85, v101, v85
    v_cvt_pk_bf16_f32 v110, v84, v85
    v_fma_f32 v102, v94, v102, 1.0
    v_rcp_f32 v102, v102
    v_fma_f32 v103, v95, 0.5, 1.0
    v_fma_f32 v103, v95, v103, 1.0
    v_rcp_f32 v103, v103
    v_fma_f32 v86, -v86, v102, v86
    v_fma_f32 v87, -v87, v103, v87
    v_cvt_pk_bf16_f32 v111, v86, v87
    buffer_store_dwordx4 v[108:111], v12, s[28:31], s61 offen offset:1024 sc1
    ds_read_b64_tr_b16 v[52:53], v8 offset:24576
    ds_read_b64_tr_b16 v[54:55], v8 offset:25088
    s_waitcnt lgkmcnt(6)
    v_mfma_f32_16x16x32_bf16 v[26:29], v[36:39], v[40:43], 0
    v_mfma_f32_32x32x16_bf16 v[72:87], v[40:43], v[128:131], 0
    s_add_u32 m0, s91, 16384
    s_nop 0
    buffer_load_dwordx4 v252, s[92:95], s90 offen lds
    buffer_load_dwordx4 v253, s[92:95], s90 offen offset:1024 lds
    s_add_u32 s90, s90, 14336
    v_add_f32 v112, v112, v113
    v_add_f32 v114, v114, v115
    v_add_f32 v112, v112, v114
    v_cvt_pk_bf16_f32 v113, v112, v112
    ds_read_b64_tr_b16 v[40:41], v8 offset:32768
    ds_read_b64_tr_b16 v[42:43], v8 offset:33280
    s_waitcnt lgkmcnt(6)
    v_mfma_f32_16x16x32_bf16 v[26:29], v[36:39], v[44:47], v[26:29]
    v_mfma_f32_32x32x16_bf16 v[72:87], v[44:47], v[144:147], v[72:87]
    v_and_b32 v114, 0xffff0000, v113
    v_sub_f32 v114, v112, v114
    v_cvt_pk_bf16_f32 v120, v112, v114
    v_cvt_pk_bf16_f32 v121, v112, v114
    s_nop 1
    v_mfma_f32_32x32x16_bf16 v[56:71], v[120:123], v[18:21], v[56:71]
    ds_read_b64_tr_b16 v[44:45], v8 offset:40960
    ds_read_b64_tr_b16 v[46:47], v8 offset:41472
    s_waitcnt lgkmcnt(6)
    v_mfma_f32_16x16x32_bf16 v[26:29], v[36:39], v[48:51], v[26:29]
    v_mfma_f32_32x32x16_bf16 v[72:87], v[48:51], v[160:163], v[72:87]
    ds_read_b64_tr_b16 v[48:49], v8 offset:49152
    ds_read_b64_tr_b16 v[50:51], v8 offset:49664
    s_waitcnt lgkmcnt(6)
    v_mfma_f32_16x16x32_bf16 v[26:29], v[36:39], v[52:55], v[26:29]
    v_mfma_f32_32x32x16_bf16 v[72:87], v[52:55], v[176:179], v[72:87]
    s_nop 1
    v_mul_f32 v56, v13, v56
    v_mul_f32 v57, v13, v57
    v_mul_f32 v58, v13, v58
    v_mul_f32 v59, v13, v59
    ds_read_b64_tr_b16 v[52:53], v9 offset:0
    ds_read_b64_tr_b16 v[54:55], v9 offset:512
    s_waitcnt lgkmcnt(6)
    v_mfma_f32_16x16x32_bf16 v[26:29], v[36:39], v[40:43], v[26:29]
    v_mfma_f32_32x32x16_bf16 v[72:87], v[40:43], v[192:195], v[72:87]
    s_add_u32 m0, s91, 32768
    s_nop 0
    buffer_load_dwordx4 v252, s[92:95], s90 offen lds
    buffer_load_dwordx4 v254, s[92:95], s90 offen offset:1024 lds
    s_add_u32 s90, s90, s96
    v_exp_f32 v88, v56
    v_exp_f32 v89, v57
    v_mul_f32 v60, v13, v60
    ds_read_b64_tr_b16 v[40:41], v10 offset:0
    ds_read_b64_tr_b16 v[42:43], v10 offset:512
    s_waitcnt lgkmcnt(6)
    v_mfma_f32_16x16x32_bf16 v[26:29], v[36:39], v[44:47], v[26:29]
    v_mfma_f32_32x32x16_bf16 v[72:87], v[44:47], v[208:211], v[72:87]
    v_exp_f32 v90, v58
    v_exp_f32 v91, v59
    v_fma_f32 v96, v88, 0.5, 1.0
    v_fma_f32 v97, v89, 0.5, 1.0
    v_fma_f32 v96, v88, v96, 1.0
    v_fma_f32 v97, v89, v97, 1.0
    ds_read_b64_tr_b16 v[44:45], v11 offset:0
    ds_read_b64_tr_b16 v[46:47], v11 offset:512
    s_waitcnt lgkmcnt(6)
    v_mfma_f32_16x16x32_bf16 v[26:29], v[36:39], v[48:51], v[26:29]
    v_mfma_f32_32x32x16_bf16 v[72:87], v[48:51], v[224:227], v[72:87]
    v_rcp_f32 v96, v96
    v_rcp_f32 v97, v97
    v_fma_f32 v98, v90, 0.5, 1.0
    v_fma_f32 v99, v91, 0.5, 1.0
    v_fma_f32 v98, v90, v98, 1.0
    v_fma_f32 v99, v91, v99, 1.0
    ds_read_b64_tr_b16 v[48:49], v9 offset:8192
    ds_read_b64_tr_b16 v[50:51], v9 offset:8704
    s_waitcnt lgkmcnt(6)
    v_mfma_f32_32x32x16_bf16 v[72:87], v[52:55], v[132:135], v[72:87]
    v_rcp_f32 v98, v98
    v_rcp_f32 v99, v99
    v_fma_f32 v56, -v56, v96, v56
    v_fma_f32 v57, -v57, v97, v57
    ds_read_b64_tr_b16 v[52:53], v10 offset:8192
    ds_read_b64_tr_b16 v[54:55], v10 offset:8704
    s_waitcnt lgkmcnt(6)
    v_mfma_f32_32x32x16_bf16 v[72:87], v[40:43], v[136:139], v[72:87]
    s_add_u32 m0, s91, 114688
    s_nop 0
    buffer_load_dwordx4 v252, s[92:95], s90 offen lds
    buffer_load_dwordx4 v253, s[92:95], s90 offen offset:1024 lds
    s_add_u32 s90, s90, 14336
    v_exp_f32 v92, v60
    v_cvt_pk_bf16_f32 v104, v56, v57
    ds_read_b64_tr_b16 v[40:41], v11 offset:8192
    ds_read_b64_tr_b16 v[42:43], v11 offset:8704
    s_waitcnt lgkmcnt(6)
    v_mfma_f32_32x32x16_bf16 v[72:87], v[44:47], v[140:143], v[72:87]
    v_fma_f32 v58, -v58, v98, v58
    v_fma_f32 v59, -v59, v99, v59
    v_cvt_pk_bf16_f32 v105, v58, v59
    ds_write_b32 v33, v26
    v_xor_b32 v33, 0x1800, v33
    ds_read_b64_tr_b16 v[44:45], v9 offset:16384
    ds_read_b64_tr_b16 v[46:47], v9 offset:16896
    s_waitcnt lgkmcnt(7)
    v_mfma_f32_32x32x16_bf16 v[72:87], v[48:51], v[148:151], v[72:87]
    v_mul_f32 v61, v13, v61
    v_fma_f32 v100, v92, 0.5, 1.0
    v_fma_f32 v100, v92, v100, 1.0
    v_mul_f32 v62, v13, v62
    ds_read_b64_tr_b16 v[48:49], v10 offset:16384
    ds_read_b64_tr_b16 v[50:51], v10 offset:16896
    s_waitcnt lgkmcnt(7)
    v_mfma_f32_32x32x16_bf16 v[72:87], v[52:55], v[152:155], v[72:87]
    v_exp_f32 v93, v61
    v_rcp_f32 v100, v100
    v_mul_f32 v63, v13, v63
    ds_read_b64_tr_b16 v[52:53], v11 offset:16384
    ds_read_b64_tr_b16 v[54:55], v11 offset:16896
    s_waitcnt lgkmcnt(7)
    v_mfma_f32_32x32x16_bf16 v[72:87], v[40:43], v[156:159], v[72:87]
    s_add_u32 m0, s91, 131072
    s_nop 0
    buffer_load_dwordx4 v252, s[92:95], s90 offen lds
    buffer_load_dwordx4 v254, s[92:95], s90 offen offset:1024 lds
    s_add_u32 s90, s90, s96
    v_exp_f32 v94, v62
    v_exp_f32 v95, v63
    ds_read_b64_tr_b16 v[40:41], v9 offset:24576
    ds_read_b64_tr_b16 v[42:43], v9 offset:25088
    s_waitcnt lgkmcnt(6)
    v_mfma_f32_32x32x16_bf16 v[72:87], v[44:47], v[164:167], v[72:87]
    v_fma_f32 v101, v93, 0.5, 1.0
    v_fma_f32 v101, v93, v101, 1.0
    v_fma_f32 v60, -v60, v100, v60
    v_fma_f32 v102, v94, 0.5, 1.0
    ds_read_b64_tr_b16 v[44:45], v10 offset:24576
    ds_read_b64_tr_b16 v[46:47], v10 offset:25088
    s_waitcnt lgkmcnt(6)
    v_mfma_f32_32x32x16_bf16 v[72:87], v[48:51], v[168:171], v[72:87]
    v_rcp_f32 v101, v101
    v_fma_f32 v103, v95, 0.5, 1.0
    v_fma_f32 v102, v94, v102, 1.0
    v_fma_f32 v103, v95, v103, 1.0
    ds_read_b64_tr_b16 v[48:49], v11 offset:24576
    ds_read_b64_tr_b16 v[50:51], v11 offset:25088
    s_waitcnt lgkmcnt(6)
    v_mfma_f32_32x32x16_bf16 v[72:87], v[52:55], v[172:175], v[72:87]
    v_rcp_f32 v102, v102
    v_rcp_f32 v103, v103
    v_fma_f32 v61, -v61, v101, v61
    v_cvt_pk_bf16_f32 v106, v60, v61
    ds_read_b64_tr_b16 v[52:53], v9 offset:32768
    ds_read_b64_tr_b16 v[54:55], v9 offset:33280
    s_waitcnt lgkmcnt(6)
    v_mfma_f32_32x32x16_bf16 v[72:87], v[40:43], v[180:183], v[72:87]
    s_add_u32 m0, s91, 0
    s_nop 0
    buffer_load_dwordx4 v252, s[92:95], s90 offen lds
    buffer_load_dwordx4 v253, s[92:95], s90 offen offset:1024 lds
    s_add_u32 s90, s90, 14336
    v_fma_f32 v62, -v62, v102, v62
    v_fma_f32 v63, -v63, v103, v63
    ds_read_b64_tr_b16 v[40:41], v10 offset:32768
    ds_read_b64_tr_b16 v[42:43], v10 offset:33280
    s_waitcnt lgkmcnt(6)
    v_mfma_f32_32x32x16_bf16 v[72:87], v[44:47], v[184:187], v[72:87]
    v_cvt_pk_bf16_f32 v107, v62, v63
    buffer_store_dwordx4 v[104:107], v12, s[28:31], s62 offen offset:0 sc1
    v_mul_f32 v64, v13, v64
    v_mul_f32 v65, v13, v65
    ds_read_b64_tr_b16 v[44:45], v11 offset:32768
    ds_read_b64_tr_b16 v[46:47], v11 offset:33280
    s_waitcnt lgkmcnt(6)
    v_mfma_f32_32x32x16_bf16 v[72:87], v[48:51], v[188:191], v[72:87]
    v_exp_f32 v88, v64
    v_exp_f32 v89, v65
    v_mul_f32 v66, v13, v66
    v_mul_f32 v67, v13, v67
    ds_read_b64_tr_b16 v[48:49], v9 offset:40960
    ds_read_b64_tr_b16 v[50:51], v9 offset:41472
    s_waitcnt lgkmcnt(6)
    v_mfma_f32_32x32x16_bf16 v[72:87], v[52:55], v[196:199], v[72:87]
    v_exp_f32 v90, v66
    v_exp_f32 v91, v67
    v_fma_f32 v96, v88, 0.5, 1.0
    v_fma_f32 v97, v89, 0.5, 1.0
    ds_read_b64_tr_b16 v[52:53], v10 offset:40960
    ds_read_b64_tr_b16 v[54:55], v10 offset:41472
    s_waitcnt lgkmcnt(6)
    v_mfma_f32_32x32x16_bf16 v[72:87], v[40:43], v[200:203], v[72:87]
    v_fma_f32 v96, v88, v96, 1.0
    v_fma_f32 v97, v89, v97, 1.0
    v_fma_f32 v98, v90, 0.5, 1.0
    s_waitcnt lgkmcnt(0)
    s_barrier
    ds_read_b64_tr_b16 v[40:41], v11 offset:40960
    ds_read_b64_tr_b16 v[42:43], v11 offset:41472
    v_mfma_f32_32x32x16_bf16 v[72:87], v[44:47], v[204:207], v[72:87]
    v_rcp_f32 v96, v96
    v_rcp_f32 v97, v97
    v_fma_f32 v99, v91, 0.5, 1.0
    v_fma_f32 v98, v90, v98, 1.0
    ds_read_b64_tr_b16 v[44:45], v9 offset:49152
    ds_read_b64_tr_b16 v[46:47], v9 offset:49664
    v_mfma_f32_32x32x16_bf16 v[72:87], v[48:51], v[212:215], v[72:87]
    v_rcp_f32 v98, v98
    v_fma_f32 v64, -v64, v96, v64
    v_fma_f32 v65, -v65, v97, v65
    v_cvt_pk_bf16_f32 v108, v64, v65
    ds_read_b64_tr_b16 v[48:49], v10 offset:49152
    ds_read_b64_tr_b16 v[50:51], v10 offset:49664
    v_mfma_f32_32x32x16_bf16 v[72:87], v[52:55], v[216:219], v[72:87]
    v_fma_f32 v99, v91, v99, 1.0
    v_fma_f32 v66, -v66, v98, v66
    v_mul_f32 v68, v13, v68
    v_mul_f32 v69, v13, v69
    ds_read_b64_tr_b16 v[52:53], v11 offset:49152
    ds_read_b64_tr_b16 v[54:55], v11 offset:49664
    s_waitcnt lgkmcnt(6)
    v_mfma_f32_32x32x16_bf16 v[72:87], v[40:43], v[220:223], v[72:87]
    v_rcp_f32 v99, v99
    v_exp_f32 v92, v68
    v_mul_f32 v70, v13, v70
    v_mul_f32 v71, v13, v71
    s_waitcnt lgkmcnt(4)
    v_mfma_f32_32x32x16_bf16 v[72:87], v[44:47], v[228:231], v[72:87]
    v_exp_f32 v93, v69
    v_exp_f32 v94, v70
    v_fma_f32 v67, -v67, v99, v67
    v_cvt_pk_bf16_f32 v109, v66, v67
    s_waitcnt lgkmcnt(2)
    v_mfma_f32_32x32x16_bf16 v[72:87], v[48:51], v[232:235], v[72:87]
    v_exp_f32 v95, v71
    v_fma_f32 v100, v92, 0.5, 1.0
    v_fma_f32 v101, v93, 0.5, 1.0
    v_fma_f32 v100, v92, v100, 1.0
    s_waitcnt lgkmcnt(0)
    v_mfma_f32_32x32x16_bf16 v[72:87], v[52:55], v[236:239], v[72:87]
    v_rcp_f32 v100, v100
    v_fma_f32 v101, v93, v101, 1.0
    v_fma_f32 v102, v94, 0.5, 1.0
    v_fma_f32 v103, v95, 0.5, 1.0
    v_rcp_f32 v101, v101
    v_fma_f32 v68, -v68, v100, v68
    v_fma_f32 v102, v94, v102, 1.0
    v_fma_f32 v103, v95, v103, 1.0
    v_rcp_f32 v102, v102
    v_rcp_f32 v103, v103
    v_fma_f32 v69, -v69, v101, v69
    v_cvt_pk_bf16_f32 v110, v68, v69
    v_fma_f32 v70, -v70, v102, v70
    v_fma_f32 v71, -v71, v103, v71
    v_cvt_pk_bf16_f32 v111, v70, v71
    buffer_store_dwordx4 v[108:111], v12, s[28:31], s62 offen offset:1024 sc1
    ds_read_b128 v[112:115], v34
    v_xor_b32 v34, 0x1800, v34
    s_waitcnt lgkmcnt(0)
    v_add_f32 v112, v112, v113
    v_add_f32 v114, v114, v115
    v_add_f32 v112, v112, v114
    v_cvt_pk_bf16_f32 v113, v112, v112
    v_and_b32 v114, 0xffff0000, v113
    v_sub_f32 v114, v112, v114
    v_cvt_pk_bf16_f32 v124, v112, v114
    v_cvt_pk_bf16_f32 v125, v112, v114
    s_nop 1
    v_mfma_f32_32x32x16_bf16 v[72:87], v[124:127], v[18:21], v[72:87]
    s_nop 11
    v_mul_f32 v72, v13, v72
    v_mul_f32 v73, v13, v73
    v_mul_f32 v74, v13, v74
    v_mul_f32 v75, v13, v75
    v_mul_f32 v76, v13, v76
    v_mul_f32 v77, v13, v77
    v_mul_f32 v78, v13, v78
    v_mul_f32 v79, v13, v79
    v_exp_f32 v88, v72
    v_exp_f32 v89, v73
    v_exp_f32 v90, v74
    v_exp_f32 v91, v75
    v_mul_f32 v80, v13, v80
    v_mul_f32 v81, v13, v81
    v_mul_f32 v82, v13, v82
    v_mul_f32 v83, v13, v83
    v_exp_f32 v92, v76
    v_exp_f32 v93, v77
    v_exp_f32 v94, v78
    v_exp_f32 v95, v79
    v_fma_f32 v96, v88, 0.5, 1.0
    v_fma_f32 v97, v89, 0.5, 1.0
    v_fma_f32 v96, v88, v96, 1.0
    v_fma_f32 v97, v89, v97, 1.0
    v_rcp_f32 v96, v96
    v_rcp_f32 v97, v97
    v_exp_f32 v88, v80
    v_exp_f32 v89, v81
    v_fma_f32 v98, v90, 0.5, 1.0
    v_fma_f32 v99, v91, 0.5, 1.0
    v_fma_f32 v98, v90, v98, 1.0
    v_fma_f32 v99, v91, v99, 1.0
    v_rcp_f32 v98, v98
    v_rcp_f32 v99, v99
    v_exp_f32 v90, v82
    v_exp_f32 v91, v83
    v_fma_f32 v72, -v72, v96, v72
    v_fma_f32 v73, -v73, v97, v73
    v_cvt_pk_bf16_f32 v104, v72, v73
    v_fma_f32 v100, v92, 0.5, 1.0
    v_fma_f32 v74, -v74, v98, v74
    v_fma_f32 v75, -v75, v99, v75
    v_cvt_pk_bf16_f32 v105, v74, v75
    v_fma_f32 v101, v93, 0.5, 1.0
    v_fma_f32 v100, v92, v100, 1.0
    v_fma_f32 v101, v93, v101, 1.0
    v_fma_f32 v102, v94, 0.5, 1.0
    v_fma_f32 v103, v95, 0.5, 1.0
    v_rcp_f32 v100, v100
    v_rcp_f32 v101, v101
    v_fma_f32 v102, v94, v102, 1.0
    v_fma_f32 v103, v95, v103, 1.0
    v_fma_f32 v96, v88, 0.5, 1.0
    v_fma_f32 v97, v89, 0.5, 1.0
    v_fma_f32 v96, v88, v96, 1.0
    v_fma_f32 v97, v89, v97, 1.0
    v_rcp_f32 v102, v102
    v_rcp_f32 v103, v103
    v_rcp_f32 v96, v96
    v_rcp_f32 v97, v97
    v_fma_f32 v76, -v76, v100, v76
    v_fma_f32 v77, -v77, v101, v77
    v_cvt_pk_bf16_f32 v106, v76, v77
    v_fma_f32 v98, v90, 0.5, 1.0
    v_fma_f32 v78, -v78, v102, v78
    v_fma_f32 v79, -v79, v103, v79
    v_cvt_pk_bf16_f32 v107, v78, v79
    buffer_store_dwordx4 v[104:107], v12, s[28:31], s63 offen offset:0 sc1
    v_fma_f32 v80, -v80, v96, v80
    v_fma_f32 v81, -v81, v97, v81
    v_cvt_pk_bf16_f32 v108, v80, v81
    v_fma_f32 v99, v91, 0.5, 1.0
    v_fma_f32 v98, v90, v98, 1.0
    v_fma_f32 v99, v91, v99, 1.0
    v_mul_f32 v84, v13, v84
    v_mul_f32 v85, v13, v85
    v_mul_f32 v86, v13, v86
    v_mul_f32 v87, v13, v87
    v_rcp_f32 v98, v98
    v_rcp_f32 v99, v99
    v_exp_f32 v92, v84
    v_exp_f32 v93, v85
    v_exp_f32 v94, v86
    v_exp_f32 v95, v87
    v_fma_f32 v82, -v82, v98, v82
    v_fma_f32 v83, -v83, v99, v83
    v_cvt_pk_bf16_f32 v109, v82, v83
    v_fma_f32 v100, v92, 0.5, 1.0
    v_fma_f32 v101, v93, 0.5, 1.0
    v_fma_f32 v100, v92, v100, 1.0
    v_rcp_f32 v100, v100
    v_fma_f32 v101, v93, v101, 1.0
    v_fma_f32 v102, v94, 0.5, 1.0
    v_fma_f32 v103, v95, 0.5, 1.0
    v_fma_f32 v102, v94, v102, 1.0
    v_fma_f32 v103, v95, v103, 1.0
    v_rcp_f32 v101, v101
    v_rcp_f32 v102, v102
    v_rcp_f32 v103, v103
    v_fma_f32 v84, -v84, v100, v84
    v_fma_f32 v85, -v85, v101, v85
    v_cvt_pk_bf16_f32 v110, v84, v85
    v_fma_f32 v86, -v86, v102, v86
    v_fma_f32 v87, -v87, v103, v87
    v_cvt_pk_bf16_f32 v111, v86, v87
    buffer_store_dwordx4 v[108:111], v12, s[28:31], s63 offen offset:1024 sc1
    s_branch FFN_DONE
FFN_IDLE:
    ds_read_b128 v[112:115], v34
    v_xor_b32 v34, 0x1800, v34
    v_mfma_f32_32x32x16_bf16 v[56:71], v[44:47], v[228:231], v[56:71]
    v_exp_f32 v93, v85
    v_exp_f32 v94, v86
    v_fma_f32 v83, -v83, v99, v83
    v_cvt_pk_bf16_f32 v109, v82, v83
    v_mfma_f32_32x32x16_bf16 v[56:71], v[48:51], v[232:235], v[56:71]
    v_fma_f32 v100, v92, 0.5, 1.0
    v_fma_f32 v101, v93, 0.5, 1.0
    v_fma_f32 v100, v92, v100, 1.0
    v_fma_f32 v101, v93, v101, 1.0
    v_mfma_f32_32x32x16_bf16 v[56:71], v[52:55], v[236:239], v[56:71]
    v_rcp_f32 v100, v100
    v_rcp_f32 v101, v101
    v_mul_f32 v87, v13, v87
    v_fma_f32 v102, v94, 0.5, 1.0
    v_exp_f32 v95, v87
    v_fma_f32 v84, -v84, v100, v84
    v_fma_f32 v85, -v85, v101, v85
    v_cvt_pk_bf16_f32 v110, v84, v85
    v_fma_f32 v102, v94, v102, 1.0
    s_waitcnt lgkmcnt(0)
    v_add_f32 v112, v112, v113
    v_add_f32 v114, v114, v115
    v_add_f32 v112, v112, v114
    v_rcp_f32 v102, v102
    v_fma_f32 v103, v95, 0.5, 1.0
    v_fma_f32 v103, v95, v103, 1.0
    v_cvt_pk_bf16_f32 v113, v112, v112
    v_and_b32 v114, 0xffff0000, v113
    v_sub_f32 v114, v112, v114
    v_cvt_pk_bf16_f32 v120, v112, v114
    v_cvt_pk_bf16_f32 v121, v112, v114
    v_rcp_f32 v103, v103
    v_fma_f32 v86, -v86, v102, v86
    v_mfma_f32_32x32x16_bf16 v[56:71], v[120:123], v[18:21], v[56:71]
    v_fma_f32 v87, -v87, v103, v87
    v_cvt_pk_bf16_f32 v111, v86, v87
    buffer_store_dwordx4 v[108:111], v12, s[28:31], s61 offen offset:1024 sc1
    s_nop 8
    v_mul_f32 v56, v13, v56
    v_mul_f32 v57, v13, v57
    v_mul_f32 v58, v13, v58
    v_mul_f32 v59, v13, v59
    v_mul_f32 v60, v13, v60
    v_mul_f32 v61, v13, v61
    v_mul_f32 v62, v13, v62
    v_mul_f32 v63, v13, v63
    v_exp_f32 v88, v56
    v_exp_f32 v89, v57
    v_exp_f32 v90, v58
    v_exp_f32 v91, v59
    v_mul_f32 v64, v13, v64
    v_mul_f32 v65, v13, v65
    v_mul_f32 v66, v13, v66
    v_mul_f32 v67, v13, v67
    v_exp_f32 v92, v60
    v_exp_f32 v93, v61
    v_exp_f32 v94, v62
    v_exp_f32 v95, v63
    v_fma_f32 v96, v88, 0.5, 1.0
    v_fma_f32 v97, v89, 0.5, 1.0
    v_fma_f32 v96, v88, v96, 1.0
    v_fma_f32 v97, v89, v97, 1.0
    v_rcp_f32 v96, v96
    v_rcp_f32 v97, v97
    v_exp_f32 v88, v64
    v_exp_f32 v89, v65
    v_fma_f32 v98, v90, 0.5, 1.0
    v_fma_f32 v99, v91, 0.5, 1.0
    v_fma_f32 v98, v90, v98, 1.0
    v_fma_f32 v99, v91, v99, 1.0
    v_rcp_f32 v98, v98
    v_rcp_f32 v99, v99
    v_exp_f32 v90, v66
    v_exp_f32 v91, v67
    v_fma_f32 v56, -v56, v96, v56
    v_fma_f32 v57, -v57, v97, v57
    v_cvt_pk_bf16_f32 v104, v56, v57
    v_fma_f32 v100, v92, 0.5, 1.0
    v_fma_f32 v58, -v58, v98, v58
    v_fma_f32 v59, -v59, v99, v59
    v_cvt_pk_bf16_f32 v105, v58, v59
    v_fma_f32 v101, v93, 0.5, 1.0
    v_fma_f32 v100, v92, v100, 1.0
    v_fma_f32 v101, v93, v101, 1.0
    v_fma_f32 v102, v94, 0.5, 1.0
    v_fma_f32 v103, v95, 0.5, 1.0
    v_rcp_f32 v100, v100
    v_rcp_f32 v101, v101
    v_fma_f32 v102, v94, v102, 1.0
    v_fma_f32 v103, v95, v103, 1.0
    v_fma_f32 v96, v88, 0.5, 1.0
    v_fma_f32 v97, v89, 0.5, 1.0
    v_fma_f32 v96, v88, v96, 1.0
    v_fma_f32 v97, v89, v97, 1.0
    v_rcp_f32 v102, v102
    v_rcp_f32 v103, v103
    v_rcp_f32 v96, v96
    v_rcp_f32 v97, v97
    v_fma_f32 v60, -v60, v100, v60
    v_fma_f32 v61, -v61, v101, v61
    v_cvt_pk_bf16_f32 v106, v60, v61
    v_fma_f32 v98, v90, 0.5, 1.0
    v_fma_f32 v62, -v62, v102, v62
    v_fma_f32 v63, -v63, v103, v63
    v_cvt_pk_bf16_f32 v107, v62, v63
    buffer_store_dwordx4 v[104:107], v12, s[28:31], s62 offen offset:0 sc1
    v_fma_f32 v64, -v64, v96, v64
    v_fma_f32 v65, -v65, v97, v65
    v_cvt_pk_bf16_f32 v108, v64, v65
    v_fma_f32 v99, v91, 0.5, 1.0
    v_fma_f32 v98, v90, v98, 1.0
    v_fma_f32 v99, v91, v99, 1.0
    v_mul_f32 v68, v13, v68
    v_mul_f32 v69, v13, v69
    v_mul_f32 v70, v13, v70
    v_mul_f32 v71, v13, v71
    v_rcp_f32 v98, v98
    v_rcp_f32 v99, v99
    v_exp_f32 v92, v68
    v_exp_f32 v93, v69
    v_exp_f32 v94, v70
    v_exp_f32 v95, v71
    v_fma_f32 v66, -v66, v98, v66
    v_fma_f32 v67, -v67, v99, v67
    v_cvt_pk_bf16_f32 v109, v66, v67
    v_fma_f32 v100, v92, 0.5, 1.0
    v_fma_f32 v101, v93, 0.5, 1.0
    v_fma_f32 v100, v92, v100, 1.0
    v_rcp_f32 v100, v100
    v_fma_f32 v101, v93, v101, 1.0
    v_fma_f32 v102, v94, 0.5, 1.0
    v_fma_f32 v103, v95, 0.5, 1.0
    v_fma_f32 v102, v94, v102, 1.0
    v_fma_f32 v103, v95, v103, 1.0
    v_rcp_f32 v101, v101
    v_rcp_f32 v102, v102
    v_rcp_f32 v103, v103
    v_fma_f32 v68, -v68, v100, v68
    v_fma_f32 v69, -v69, v101, v69
    v_cvt_pk_bf16_f32 v110, v68, v69
    v_fma_f32 v70, -v70, v102, v70
    v_fma_f32 v71, -v71, v103, v71
    v_cvt_pk_bf16_f32 v111, v70, v71
    buffer_store_dwordx4 v[108:111], v12, s[28:31], s62 offen offset:1024 sc1
    s_barrier
    s_add_u32 m0, s91, 16384
    s_nop 0
    buffer_load_dwordx4 v252, s[92:95], s90 offen lds
    buffer_load_dwordx4 v253, s[92:95], s90 offen offset:1024 lds
    s_add_u32 s90, s90, 14336
    s_add_u32 m0, s91, 32768
    s_nop 0
    buffer_load_dwordx4 v252, s[92:95], s90 offen lds
    buffer_load_dwordx4 v254, s[92:95], s90 offen offset:1024 lds
    s_add_u32 s90, s90, s96
    s_add_u32 m0, s91, 114688
    s_nop 0
    buffer_load_dwordx4 v252, s[92:95], s90 offen lds
    buffer_load_dwordx4 v253, s[92:95], s90 offen offset:1024 lds
    s_add_u32 s90, s90, 14336
    s_add_u32 m0, s91, 131072
    s_nop 0
    buffer_load_dwordx4 v252, s[92:95], s90 offen lds
    buffer_load_dwordx4 v254, s[92:95], s90 offen offset:1024 lds
    s_add_u32 s90, s90, s96
    s_add_u32 m0, s91, 0
    s_nop 0
    buffer_load_dwordx4 v252, s[92:95], s90 offen lds
    buffer_load_dwordx4 v253, s[92:95], s90 offen offset:1024 lds
    s_add_u32 s90, s90, 14336
FFN_DONE:
    s_branch P2_TAIL
ATT:
    s_lshl_b32 s72, s44, 7
    s_lshl_b32 s73, s3, 4
    s_add_u32 s52, s72, s73
    s_mul_i32 s52, s52, 896
    s_lshl_b32 s53, s3, 11
    s_and_b32 s64, s3, 1
    s_sub_u32 s54, s72, 16
    s_add_u32 s54, s54, s64
    s_mul_i32 s54, s54, 896
    s_cmp_eq_u32 s44, 0
    s_cselect_b32 s54, 1073741824, s54
    s_lshl_b32 s55, s64, 10
    s_add_u32 s55, s55, 49152
    s_mul_i32 s56, s3, 21504
    s_mul_i32 s73, s45, 112
    s_add_u32 s56, s56, s73
    s_lshl_b32 s57, s3, 10
    s_add_u32 s57, s57, 58368
    s_mov_b32 s66, 0xf7f77f7f
    s_mov_b32 s67, 0xf7f77f7f
    s_lshl_b32 s73, s3, 1
    s_lshr_b32 s71, 0x6009, s73
    s_and_b32 s71, s71, 3
    v_bfe_u32 v208, v0, 2, 3
    v_lshrrev_b32 v209, 2, v208
    s_lshl_b32 s73, s64, 1
    v_or_b32 v209, s73, v209
    v_and_b32 v210, 3, v0
    v_xor_b32 v209, v209, v210
    v_lshrrev_b32 v210, 5, v0
    v_lshl_add_u32 v209, v210, 2, v209
    v_mul_u32_u24 v208, 1792, v208
    v_lshl_add_u32 v1, v209, 4, v208
    v_bfe_u32 v208, v0, 4, 1
    v_lshlrev_b32 v208, 2, v208
    v_and_b32 v209, 7, v0
    v_xor_b32 v208, v208, v209
    v_lshrrev_b32 v209, 3, v0
    v_mul_u32_u24 v209, 2688, v209
    v_lshl_add_u32 v2, v208, 4, v209
    s_mov_b32 s26, 1204224
    s_waitcnt lgkmcnt(0)
    s_mov_b32 s20, s4
    s_mov_b32 s21, s5
    s_mov_b32 s24, s6
    s_mov_b32 s25, s7
    s_add_u32 s100, s16, 9439232
    s_addc_u32 s101, s17, 0
    s_load_dword s78, s[100:101], 0
    s_load_dwordx2 s[18:19], s[0:1], 56
    s_mov_b32 s59, 0
    s_add_u32 m0, s53, 0
    s_nop 0
    buffer_load_dwordx4 v1, s[20:23], s52 offen lds
    s_add_u32 m0, s53, 1024
    s_add_u32 s49, s52, 896
    buffer_load_dwordx4 v1, s[20:23], s49 offen lds
    s_cmp_lg_u32 s71, 1
    s_cbranch_scc1 ATT_NH0
    s_mov_b32 m0, s55
    s_nop 0
    buffer_load_dwordx4 v1, s[20:23], s54 offen lds
ATT_NH0:
    s_add_u32 m0, s57, 0
    s_mov_b64 exec, s[66:67]
    buffer_load_dwordx4 v2, s[24:27], s56 offen lds
    s_mov_b64 exec, -1
    s_add_u32 m0, s57, 8192
    s_add_u32 s49, s56, 896
    s_mov_b64 exec, s[66:67]
    buffer_load_dwordx4 v2, s[24:27], s49 offen lds
    s_mov_b64 exec, -1
    s_add_u32 m0, s57, 16384
    s_add_u32 s49, s56, 1792
    s_mov_b64 exec, s[66:67]
    buffer_load_dwordx4 v2, s[24:27], s49 offen lds
    s_mov_b64 exec, -1
    s_add_u32 s52, s52, 128
    s_add_u32 s54, s54, 128
    s_add_u32 s56, s56, 172032
    s_cmp_eq_u32 s59, 2
    s_cselect_b32 s50, -2, 1
    s_mul_i32 s49, s50, 16384
    s_add_u32 s53, s53, s49
    s_mul_i32 s49, s50, 3072
    s_add_u32 s55, s55, s49
    s_mul_i32 s49, s50, 24576
    s_add_u32 s57, s57, s49
    s_add_u32 s59, s59, 1
    s_cmp_eq_u32 s59, 3
    s_cselect_b32 s59, 0, s59
    s_barrier
    s_add_u32 m0, s53, 0
    s_nop 0
    buffer_load_dwordx4 v1, s[20:23], s52 offen lds
    s_and_b32 s46, s3, 3
    s_lshr_b32 s47, s3, 2
    s_xor_b32 s48, s46, s47
    s_and_b32 s51, s2, 0xfffffff8
    s_add_u32 s51, s51, s3
    s_mov_b32 s60, 0
    s_mov_b32 s65, 0xffff0000
    s_mov_b32 s68, -1
    s_mov_b32 s69, 0
    v_mov_b32 v52, 0x3f803f80
    v_mov_b32 v53, 0x3f803f80
    v_mov_b32 v54, 0x3f803f80
    v_mov_b32 v55, 0x3f803f80
    v_and_b32 v216, 7, v0
    v_bfe_u32 v217, v0, 1, 1
    v_lshlrev_b32 v217, 2, v217
    v_xor_b32 v217, 7, v217
    v_lshlrev_b32 v217, 4, v217
    v_lshl_add_u32 v217, v216, 7, v217
    s_lshl_b32 s72, s3, 10
    s_add_u32 s72, s72, 58368
    v_add_u32 v217, s72, v217
    v_lshrrev_b32 v216, 3, v0
    v_lshl_add_u32 v216, v216, 13, v217
    ds_write_b128 v216, v[52:55]
    v_add_u32 v217, 65536, v217
    ds_write_b128 v217, v[52:55]
    v_lshlrev_b32 v216, 4, v0
    s_min_u32 s72, s3, 2
    s_mul_i32 s72, s72, 3072
    s_add_u32 s72, s72, 51200
    v_add_u32 v216, s72, v216
    ds_write_b128 v216, v[52:55]
    v_lshrrev_b32 v216, 5, v0
    s_add_u32 m0, s53, 1024
    s_add_u32 s49, s52, 896
    buffer_load_dwordx4 v1, s[20:23], s49 offen lds
    v_and_b32 v217, 31, v0
    v_mul_u32_u24 v218, 384, v216
    v_lshl_add_u32 v218, v217, 2, v218
    v_mov_b32 v219, 0
    v_add_u32 v218, 158720, v218
    ds_write_b32 v218, v219
    v_mov_b32 v10, 0
    v_mov_b32 v11, 0
    v_mov_b32 v12, 0
    v_mov_b32 v13, 0
    v_bfe_u32 v218, v0, 3, 1
    v_lshlrev_b32 v218, 11, v218
    v_bfe_u32 v219, v0, 4, 1
    v_lshl_add_u32 v218, v219, 10, v218
    v_and_b32 v220, 7, v0
    v_lshlrev_b32 v220, 6, v220
    v_add_u32 v218, v218, v220
    s_lshl_b32 s72, s64, 1
    v_xor_b32 v221, s72, v216
    v_bfe_u32 v222, v0, 2, 2
    v_xor_b32 v222, v222, v221
    v_lshl_add_u32 v218, v222, 4, v218
    s_lshl_b32 s72, s46, 12
    v_add_u32 v4, s72, v218
    v_xor_b32 v5, 32, v4
    v_bfe_u32 v222, v0, 2, 1
    v_lshl_or_b32 v222, v219, 1, v222
    v_xor_b32 v222, v222, v221
    v_lshl_add_u32 v222, v222, 4, v220
    v_lshl_add_u32 v222, v219, 10, v222
    v_and_b32 v223, 8, v0
    v_cmp_eq_u32 vcc, 0, v223
    v_mov_b32 v223, 2048
    v_xor_b32 v224, 32, v222
    s_cmp_lg_u32 s71, 1
    s_cbranch_scc1 ATT_NH1
    s_mov_b32 m0, s55
    s_nop 0
    buffer_load_dwordx4 v1, s[20:23], s54 offen lds
ATT_NH1:
    v_cndmask_b32 v222, v222, v223, vcc
    v_cndmask_b32 v224, v224, v223, vcc
    v_add_u32 v8, 49152, v222
    v_add_u32 v9, 49152, v224
    v_bfe_u32 v222, v0, 2, 2
    v_lshl_add_u32 v222, v216, 3, v222
    v_lshlrev_b32 v222, 7, v222
    v_and_b32 v223, 3, v0
    v_lshlrev_b32 v223, 3, v223
    v_lshl_add_u32 v223, v219, 5, v223
    v_cmp_eq_u32 vcc, 56, v223
    s_mul_i32 s72, s47, 56
    v_add_u32 v223, s72, v223
    v_bfe_u32 v224, v0, 3, 1
    v_lshlrev_b32 v224, 6, v224
    v_xor_b32 v223, v223, v224
    v_add_u32 v222, v222, v223
    v_lshlrev_b32 v223, 10, v216
    v_add_u32 v223, 312, v223
    s_cmp_eq_u32 s47, 0
    s_cselect_b64 s[72:73], vcc, 0
    v_cndmask_b32 v222, v222, v223, s[72:73]
    s_lshl_b32 s74, s64, 11
    s_add_u32 s74, s74, 58368
    v_add_u32 v6, s74, v222
    s_xor_b32 s74, s64, 1
    s_lshl_b32 s74, s74, 11
    s_add_u32 s74, s74, 58368
    v_add_u32 v7, s74, v222
    v_and_b32 v222, 3, v0
    v_bfe_u32 v223, v0, 2, 1
    v_bfe_u32 v24, v0, 4, 1
    v_xor_b32 v223, v223, v24
    v_or_b32 v222, v222, v223
    s_add_u32 m0, s57, 0
    s_mov_b64 exec, s[66:67]
    buffer_load_dwordx4 v2, s[24:27], s56 offen lds
    s_mov_b64 exec, -1
    v_cmp_eq_u32 vcc, 0, v222
    v_mov_b32 v223, 0x3f803f80
    s_nop 0
    v_cndmask_b32 v24, 0, v223, vcc
    v_mov_b32 v25, v24
    v_mov_b32 v26, v24
    v_mov_b32 v27, v24
    s_lshl_b32 s72, s46, 9
    s_add_u32 s72, s72, 155648
    v_lshlrev_b32 v222, 4, v217
    v_add_u32 v29, s72, v222
    s_min_u32 s72, s71, 1
    s_lshl_b32 s72, s72, 3
    v_lshl_add_u32 v222, v216, 2, v29
    v_add_u32 v28, s72, v222
    v_lshlrev_b32 v222, 5, v217
    v_add_u32 v31, 157696, v222
    s_lshr_b32 s72, s71, 1
    s_lshl_b32 s74, s47, 1
    s_add_u32 s72, s72, s74
    s_lshl_b32 s72, s72, 3
    v_lshl_add_u32 v222, v216, 2, v31
    v_add_u32 v30, s72, v222
    s_mul_i32 s72, s47, 384
    s_add_u32 s72, s72, 158720
    v_lshlrev_b32 v222, 6, v216
    v_add_u32 v33, s72, v222
    v_bfe_u32 v222, v0, 2, 1
    v_lshlrev_b32 v222, 4, v222
    v_bfe_u32 v223, v0, 3, 2
    v_lshl_add_u32 v222, v223, 2, v222
    v_and_b32 v223, 3, v0
    v_add_u32 v222, v222, v223
    v_lshlrev_b32 v222, 2, v222
    v_add_u32 v32, s72, v222
    s_add_u32 m0, s57, 8192
    s_add_u32 s49, s56, 896
    s_mov_b64 exec, s[66:67]
    buffer_load_dwordx4 v2, s[24:27], s49 offen lds
    s_mov_b64 exec, -1
    v_and_b32 v222, 15, v0
    v_bfe_u32 v224, v0, 1, 2
    v_lshlrev_b32 v223, 1, v216
    v_xor_b32 v223, v223, v224
    v_lshlrev_b32 v223, 4, v223
    v_lshl_add_u32 v223, v222, 6, v223
    v_mul_u32_u24 v225, 5120, v219
    v_add_u32 v223, v223, v225
    s_mul_i32 s72, s47, 30720
    s_lshl_b32 s74, s46, 10
    s_add_u32 s72, s72, s74
    s_add_u32 s72, s72, 49152
    v_add_u32 v223, s72, v223
    v_add_u32 v34, 1024, v223
    v_xor_b32 v35, 16, v34
    v_lshrrev_b32 v223, 4, v0
    v_xor_b32 v225, v223, v224
    v_lshlrev_b32 v225, 4, v225
    v_lshl_add_u32 v225, v222, 6, v225
    v_add_u32 v36, s72, v225
    v_and_b32 v225, 1, v223
    v_lshlrev_b32 v225, 1, v225
    v_bfe_u32 v226, v0, 1, 1
    v_xor_b32 v225, v225, v226
    v_bfe_u32 v226, v0, 3, 1
    v_xor_b32 v225, v225, v226
    v_lshlrev_b32 v225, 4, v225
    v_and_b32 v226, 1, v0
    v_lshl_add_u32 v225, v226, 3, v225
    v_lshrrev_b32 v226, 2, v222
    v_lshl_add_u32 v226, v223, 2, v226
    v_lshl_add_u32 v225, v226, 6, v225
    v_add_u32 v37, s72, v225
    v_xor_b32 v38, 32, v37
    s_add_u32 m0, s57, 16384
    s_add_u32 s49, s56, 1792
    s_mov_b64 exec, s[66:67]
    buffer_load_dwordx4 v2, s[24:27], s49 offen lds
    s_mov_b64 exec, -1
    v_lshrrev_b32 v225, 1, v223
    v_lshlrev_b32 v225, 10, v225
    v_and_b32 v226, 1, v223
    v_lshl_add_u32 v225, v226, 9, v225
    v_lshl_add_u32 v3, v222, 4, v225
    s_lshl_b32 s72, s44, 2
    s_add_u32 s72, s72, s46
    s_mul_i32 s72, s72, 144
    s_lshl_b32 s74, s45, 1
    s_add_u32 s74, s74, s47
    s_lshl_b32 s74, s74, 1
    s_add_u32 s72, s72, s74
    s_lshl_b32 s70, s72, 10
    v_lshlrev_b32 v225, 2, v223
    v_sub_u32 v225, v222, v225
    v_mov_b32 v226, 0xce6e6b28
    s_or_b32 s72, s44, s46
    s_cmp_eq_u32 s72, 0
    s_cselect_b32 s74, 1000, 0
    v_subrev_u32 v227, 0, v225
    v_cmp_gt_u32 vcc, 8, v227
    s_nop 1
    v_cndmask_b32 v40, v226, 0, vcc
    v_add_u32 v227, s74, v227
    v_cmp_gt_i32 vcc, -8, v227
    s_nop 1
    v_cndmask_b32 v44, v226, 0, vcc
    v_subrev_u32 v227, 1, v225
    v_cmp_gt_u32 vcc, 8, v227
    s_nop 1
    v_cndmask_b32 v41, v226, 0, vcc
    v_add_u32 v227, s74, v227
    v_cmp_gt_i32 vcc, -8, v227
    s_nop 1
    v_cndmask_b32 v45, v226, 0, vcc
    v_subrev_u32 v227, 2, v225
    v_cmp_gt_u32 vcc, 8, v227
    s_nop 1
    v_cndmask_b32 v42, v226, 0, vcc
    s_add_u32 s52, s52, 128
    s_add_u32 s54, s54, 128
    s_add_u32 s56, s56, 172032
    s_cmp_eq_u32 s59, 2
    s_cselect_b32 s50, -2, 1
    s_mul_i32 s49, s50, 16384
    s_add_u32 s53, s53, s49
    s_mul_i32 s49, s50, 3072
    s_add_u32 s55, s55, s49
    s_mul_i32 s49, s50, 24576
    s_add_u32 s57, s57, s49
    s_add_u32 s59, s59, 1
    s_cmp_eq_u32 s59, 3
    s_cselect_b32 s59, 0, s59
    v_mul_u32_u24 v251, 57, v0
    v_lshrrev_b32 v251, 9, v251
    v_mul_u32_u24 v250, 9, v251
    v_sub_u32 v250, v0, v250
    v_mul_u32_u24 v249, 86, v250
    v_lshrrev_b32 v249, 8, v249
    v_lshl_add_u32 v250, v249, 2, v250
    v_lshlrev_b32 v250, 7, v250
    v_mul_u32_u24 v251, 2688, v251
    v_add_u32 v250, v250, v251
    s_and_b32 s75, s44, 7
    s_lshl_b32 s75, s75, 1
    s_and_b32 s49, s45, 1
    s_add_u32 s75, s75, s49
    s_mul_i32 s75, s75, 10752
    s_lshr_b32 s49, s45, 1
    s_mul_i32 s49, s49, 224
    s_and_b32 s49, s49, 0xffffff80
    s_add_u32 s75, s75, s49
    s_lshr_b32 s76, s3, 2
    s_add_u32 s76, s76, 2
    s_cmp_lg_u32 s71, 1
    s_cbranch_scc1 ATT_T3
    s_mul_i32 s49, s76, 172032
    s_add_u32 s49, s49, s75
    s_mov_b32 exec_hi, 15
    buffer_load_dword v251, v250, s[24:27], s49 offen
    s_mov_b32 exec_hi, -1
ATT_T3:
    s_add_u32 s76, s3, 2
    v_add_u32 v227, s74, v227
    v_cmp_gt_i32 vcc, -8, v227
    s_nop 1
    v_cndmask_b32 v46, v226, 0, vcc
    v_subrev_u32 v227, 3, v225
    v_cmp_gt_u32 vcc, 8, v227
    s_nop 1
    v_cndmask_b32 v43, v226, 0, vcc
    v_add_u32 v227, s74, v227
    v_cmp_gt_i32 vcc, -8, v227
    s_nop 1
    v_cndmask_b32 v47, v226, 0, vcc
    v_mov_b32 v226, 0xffff
    v_cmp_eq_u32 vcc, 0, v44
    s_nop 1
    v_cndmask_b32 v48, 0, v226, vcc
    v_cmp_eq_u32 vcc, 0, v45
    s_nop 1
    v_cndmask_b32 v227, 0, v226, vcc
    v_lshl_or_b32 v48, v227, 16, v48
    v_cmp_eq_u32 vcc, 0, v46
    s_nop 1
    v_cndmask_b32 v49, 0, v226, vcc
    v_cmp_eq_u32 vcc, 0, v47
    s_nop 1
    v_cndmask_b32 v227, 0, v226, vcc
    v_lshl_or_b32 v49, v227, 16, v49
    v_cmp_eq_u32 vcc, 0, v40
    s_nop 1
    v_cndmask_b32 v50, 0, v226, vcc
    v_cmp_eq_u32 vcc, 0, v41
    s_nop 1
    v_cndmask_b32 v227, 0, v226, vcc
    v_lshl_or_b32 v50, v227, 16, v50
    v_cmp_eq_u32 vcc, 0, v42
    s_nop 1
    v_cndmask_b32 v51, 0, v226, vcc
    v_cmp_eq_u32 vcc, 0, v43
    s_nop 1
    v_cndmask_b32 v227, 0, v226, vcc
    v_lshl_or_b32 v51, v227, 16, v51
    s_cmp_lt_u32 s51, 196
    s_cselect_b32 s32, s10, s8
    s_cselect_b32 s33, s11, s9
    s_mov_b32 s34, 401408
    s_cselect_b32 s34, 1605632, s34
    s_mov_b32 s35, 0x20000
    s_cselect_b32 s77, 0, 196
    s_sub_u32 s77, s51, s77
    s_lshl_b32 s77, s77, 13
    s_mov_b32 s79, 1073741824
    s_cmp_eq_u32 s47, 0
    s_cselect_b32 s49, s79, s77
    s_cselect_b32 s77, s77, s79
    s_mov_b32 s79, s49
    s_mov_b32 s28, s16
    s_mov_b32 s29, s17
    s_mov_b32 s30, 9441280
    s_mov_b32 s31, 0x20000
    s_cmp_eq_u32 s71, 1
    s_cbranch_scc1 ATT_K
    s_cmp_eq_u32 s71, 2
    s_cbranch_scc1 ATT_V
ATT_N:
    s_waitcnt vmcnt(5) lgkmcnt(0)
    s_barrier
    ds_read_b128 v[128:131], v4 offset:0
    ds_read_b64_tr_b16 v[132:133], v6 offset:0
    ds_read_b64_tr_b16 v[134:135], v6 offset:512
    s_add_u32 m0, s53, 0
    s_nop 0
    buffer_load_dwordx4 v1, s[20:23], s52 offen lds
    ds_read_b64_tr_b16 v[136:137], v6 offset:8192
    ds_read_b64_tr_b16 v[138:139], v6 offset:8704
    ds_read_b64_tr_b16 v[140:141], v6 offset:16384
    ds_read_b64_tr_b16 v[142:143], v6 offset:16896
    s_add_u32 m0, s53, 1024
    s_add_u32 s49, s52, 896
    buffer_load_dwordx4 v1, s[20:23], s49 offen lds
    ds_read_b128 v[148:151], v5 offset:0
    ds_read_b64_tr_b16 v[152:153], v7 offset:0
    ds_read_b64_tr_b16 v[154:155], v7 offset:512
    ds_read_b64_tr_b16 v[156:157], v7 offset:8192
    ds_read_b64_tr_b16 v[158:159], v7 offset:8704
    s_add_u32 m0, s57, 0
    s_mov_b64 exec, s[66:67]
    buffer_load_dwordx4 v2, s[24:27], s56 offen lds
    s_mov_b64 exec, -1
    ds_read_b64_tr_b16 v[160:161], v7 offset:16384
    ds_read_b64_tr_b16 v[162:163], v7 offset:16896
    s_cmp_eq_u32 s60, 2
    s_cselect_b32 s50, -2, 1
    s_mul_i32 s61, s50, 16384
    s_mul_i32 s62, s50, 3072
    s_mul_i32 s63, s50, 24576
    s_add_u32 s60, s60, 1
    s_cmp_eq_u32 s60, 3
    s_cselect_b32 s60, 0, s60
    ds_read_b128 v[168:171], v4 offset:512
    ds_read_b64_tr_b16 v[172:173], v6 offset:4096
    ds_read_b64_tr_b16 v[174:175], v6 offset:4608
    s_waitcnt lgkmcnt(10)
    v_mfma_f32_16x16x32_bf16 v[20:23], v[24:27], v[132:135], 0
    v_mfma_f32_32x32x16_bf16 v[64:79], v[132:135], v[128:131], 0
    s_add_u32 m0, s57, 8192
    s_add_u32 s49, s56, 896
    s_mov_b64 exec, s[66:67]
    buffer_load_dwordx4 v2, s[24:27], s49 offen lds
    s_mov_b64 exec, -1
    v_and_b32 v14, s65, v128
    v_lshlrev_b32 v15, 16, v128
    v_fmac_f32 v10, v14, v14
    v_fmac_f32 v11, v15, v15
    ds_read_b64_tr_b16 v[176:177], v6 offset:12288
    ds_read_b64_tr_b16 v[178:179], v6 offset:12800
    v_mfma_f32_32x32x16_bf16 v[80:95], v[136:139], v[128:131], 0
    v_and_b32 v14, s65, v129
    v_lshlrev_b32 v15, 16, v129
    v_fmac_f32 v10, v14, v14
    v_fmac_f32 v11, v15, v15
    ds_read_b64_tr_b16 v[180:181], v6 offset:20480
    ds_read_b64_tr_b16 v[182:183], v6 offset:20992
    v_mfma_f32_32x32x16_bf16 v[96:111], v[140:143], v[128:131], 0
    s_add_u32 m0, s57, 16384
    s_add_u32 s49, s56, 1792
    s_mov_b64 exec, s[66:67]
    buffer_load_dwordx4 v2, s[24:27], s49 offen lds
    s_mov_b64 exec, -1
    s_add_u32 s52, s52, 128
    s_add_u32 s54, s54, 128
    s_add_u32 s56, s56, 172032
    s_cmp_eq_u32 s59, 2
    s_cselect_b32 s50, -2, 1
    s_mul_i32 s49, s50, 16384
    s_add_u32 s53, s53, s49
    s_mul_i32 s49, s50, 3072
    s_add_u32 s55, s55, s49
    s_mul_i32 s49, s50, 24576
    s_add_u32 s57, s57, s49
    s_add_u32 s59, s59, 1
    s_cmp_eq_u32 s59, 3
    s_cselect_b32 s59, 0, s59
    v_and_b32 v14, s65, v130
    v_lshlrev_b32 v15, 16, v130
    ds_read_b128 v[188:191], v5 offset:512
    ds_read_b64_tr_b16 v[192:193], v7 offset:4096
    ds_read_b64_tr_b16 v[194:195], v7 offset:4608
    ds_read_b64_tr_b16 v[196:197], v7 offset:12288
    s_waitcnt lgkmcnt(11)
    v_mfma_f32_32x32x16_bf16 v[64:79], v[152:155], v[148:151], v[64:79]
    v_add_u32 v4, s61, v4
    v_add_u32 v6, s63, v6
    v_fmac_f32 v10, v14, v14
    v_fmac_f32 v11, v15, v15
    ds_read_b64_tr_b16 v[198:199], v7 offset:12800
    ds_read_b64_tr_b16 v[200:201], v7 offset:20480
    ds_read_b64_tr_b16 v[202:203], v7 offset:20992
    v_mfma_f32_32x32x16_bf16 v[80:95], v[156:159], v[148:151], v[80:95]
    v_and_b32 v14, s65, v131
    v_lshlrev_b32 v15, 16, v131
    v_fmac_f32 v10, v14, v14
    v_fmac_f32 v11, v15, v15
    v_mfma_f32_32x32x16_bf16 v[96:111], v[160:163], v[148:151], v[96:111]
    v_add_u32 v5, s61, v5
    v_add_u32 v7, s63, v7
    s_lshr_b32 s49, s2, 3
    s_mul_i32 s97, s49, 37
    s_lshr_b32 s97, s97, 8
    s_mul_i32 s50, s97, 7
    s_sub_u32 s98, s49, s50
    s_and_b32 s49, s2, 7
    s_lshl_b32 s49, s49, 2
    s_add_u32 s97, s97, s49
    s_mov_b32 s91, s3
    s_sub_u32 s49, s91, 2
    s_mul_i32 s99, s49, 19
    s_cmp_eq_u32 s91, 7
    s_cselect_b32 s99, 94, s99
    s_mul_i32 s49, s91, 200704
    s_mul_i32 s50, s99, 14336
    s_cmp_lt_u32 s91, 2
    s_cselect_b32 s90, s49, s50
    s_cselect_b32 s92, s8, s10
    s_cselect_b32 s93, s9, s11
    s_mov_b32 s94, 1605632
    s_cselect_b32 s94, 401408, s94
    s_mov_b32 s95, 0x20000
    s_mov_b32 s96, 14336
    s_cselect_b32 s96, 10752, s96
    s_mov_b32 s49, 6144
    s_cselect_b32 s49, 2560, s49
    s_cselect_b32 s50, 1073741824, 0
    s_cselect_b64 vcc, -1, 0
    v_lshrrev_b32 v240, 3, v0
    v_and_b32 v241, 7, v0
    v_bfe_u32 v242, v0, 4, 1
    v_lshlrev_b32 v242, 2, v242
    v_xor_b32 v242, v242, v241
    v_lshrrev_b32 v243, 2, v240
    v_and_b32 v244, 3, v240
    v_lshl_add_u32 v244, v243, 3, v244
    v_cndmask_b32 v240, v240, v244, vcc
    v_mul_u32_u24 v240, 896, v240
    v_lshl_add_u32 v252, v242, 4, v240
    v_add_u32 v253, s49, v252
    v_mul_lo_u32 v243, v243, s50
    v_add_u32 v254, v253, v243
    s_lshl_b32 s49, s98, 7
    s_add_u32 s90, s90, s49
    s_lshl_b32 s91, s91, 11
    s_mov_b32 s58, 4
    s_waitcnt vmcnt(5) lgkmcnt(0)
ATT_LA_N:
    s_barrier
    v_mfma_f32_16x16x32_bf16 v[20:23], v[24:27], v[172:175], v[20:23]
    v_mfma_f32_32x32x16_bf16 v[64:79], v[172:175], v[168:171], v[64:79]
    s_add_u32 m0, s53, 0
    s_nop 0
    buffer_load_dwordx4 v1, s[20:23], s52 offen lds
    ds_read_b128 v[128:131], v4 offset:0
    ds_read_b64_tr_b16 v[132:133], v6 offset:0
    ds_read_b64_tr_b16 v[134:135], v6 offset:512
    v_and_b32 v14, s65, v168
    v_lshlrev_b32 v15, 16, v168
    v_fmac_f32 v10, v14, v14
    v_fmac_f32 v11, v15, v15
    ds_read_b64_tr_b16 v[136:137], v6 offset:8192
    ds_read_b64_tr_b16 v[138:139], v6 offset:8704
    v_mfma_f32_32x32x16_bf16 v[80:95], v[176:179], v[168:171], v[80:95]
    v_and_b32 v14, s65, v169
    v_lshlrev_b32 v15, 16, v169
    v_fmac_f32 v10, v14, v14
    v_fmac_f32 v11, v15, v15
    ds_read_b64_tr_b16 v[140:141], v6 offset:16384
    ds_read_b64_tr_b16 v[142:143], v6 offset:16896
    v_mfma_f32_32x32x16_bf16 v[96:111], v[180:183], v[168:171], v[96:111]
    s_add_u32 m0, s53, 1024
    s_add_u32 s49, s52, 896
    buffer_load_dwordx4 v1, s[20:23], s49 offen lds
    v_and_b32 v14, s65, v170
    v_lshlrev_b32 v15, 16, v170
    ds_read_b128 v[148:151], v5 offset:0
    ds_read_b64_tr_b16 v[152:153], v7 offset:0
    ds_read_b64_tr_b16 v[154:155], v7 offset:512
    v_mfma_f32_32x32x16_bf16 v[64:79], v[192:195], v[188:191], v[64:79]
    v_fmac_f32 v10, v14, v14
    v_fmac_f32 v11, v15, v15
    v_and_b32 v14, s65, v171
    v_lshlrev_b32 v15, 16, v171
    ds_read_b64_tr_b16 v[156:157], v7 offset:8192
    ds_read_b64_tr_b16 v[158:159], v7 offset:8704
    v_mfma_f32_32x32x16_bf16 v[80:95], v[196:199], v[188:191], v[80:95]
    s_add_u32 m0, s57, 0
    s_mov_b64 exec, s[66:67]
    buffer_load_dwordx4 v2, s[24:27], s56 offen lds
    s_mov_b64 exec, -1
    v_fmac_f32 v10, v14, v14
    v_fmac_f32 v11, v15, v15
    ds_read_b64_tr_b16 v[160:161], v7 offset:16384
    ds_read_b64_tr_b16 v[162:163], v7 offset:16896
    v_mfma_f32_32x32x16_bf16 v[96:111], v[200:203], v[188:191], v[96:111]
    s_cmp_eq_u32 s60, 2
    s_cselect_b32 s50, -2, 1
    s_mul_i32 s61, s50, 16384
    s_mul_i32 s62, s50, 3072
    s_mul_i32 s63, s50, 24576
    s_add_u32 s60, s60, 1
    s_cmp_eq_u32 s60, 3
    s_cselect_b32 s60, 0, s60
    ds_read_b128 v[168:171], v4 offset:512
    ds_read_b64_tr_b16 v[172:173], v6 offset:4096
    ds_read_b64_tr_b16 v[174:175], v6 offset:4608
    s_waitcnt lgkmcnt(10)
    v_mfma_f32_16x16x32_bf16 v[20:23], v[24:27], v[132:135], v[20:23]
    v_mfma_f32_32x32x16_bf16 v[64:79], v[132:135], v[128:131], v[64:79]
    s_add_u32 m0, s57, 8192
    s_add_u32 s49, s56, 896
    s_mov_b64 exec, s[66:67]
    buffer_load_dwordx4 v2, s[24:27], s49 offen lds
    s_mov_b64 exec, -1
    v_and_b32 v14, s65, v128
    v_lshlrev_b32 v15, 16, v128
    v_fmac_f32 v10, v14, v14
    v_fmac_f32 v11, v15, v15
    ds_read_b64_tr_b16 v[176:177], v6 offset:12288
    ds_read_b64_tr_b16 v[178:179], v6 offset:12800
    v_mfma_f32_32x32x16_bf16 v[80:95], v[136:139], v[128:131], v[80:95]
    v_and_b32 v14, s65, v129
    v_lshlrev_b32 v15, 16, v129
    v_fmac_f32 v10, v14, v14
    v_fmac_f32 v11, v15, v15
    ds_read_b64_tr_b16 v[180:181], v6 offset:20480
    ds_read_b64_tr_b16 v[182:183], v6 offset:20992
    v_mfma_f32_32x32x16_bf16 v[96:111], v[140:143], v[128:131], v[96:111]
    s_add_u32 m0, s57, 16384
    s_add_u32 s49, s56, 1792
    s_mov_b64 exec, s[66:67]
    buffer_load_dwordx4 v2, s[24:27], s49 offen lds
    s_mov_b64 exec, -1
    s_add_u32 s52, s52, 128
    s_add_u32 s54, s54, 128
    s_add_u32 s56, s56, 172032
    s_cmp_eq_u32 s59, 2
    s_cselect_b32 s50, -2, 1
    s_mul_i32 s49, s50, 16384
    s_add_u32 s53, s53, s49
    s_mul_i32 s49, s50, 3072
    s_add_u32 s55, s55, s49
    s_mul_i32 s49, s50, 24576
    s_add_u32 s57, s57, s49
    s_add_u32 s59, s59, 1
    s_cmp_eq_u32 s59, 3
    s_cselect_b32 s59, 0, s59
    v_and_b32 v14, s65, v130
    v_lshlrev_b32 v15, 16, v130
    ds_read_b128 v[188:191], v5 offset:512
    ds_read_b64_tr_b16 v[192:193], v7 offset:4096
    ds_read_b64_tr_b16 v[194:195], v7 offset:4608
    ds_read_b64_tr_b16 v[196:197], v7 offset:12288
    s_waitcnt lgkmcnt(11)
    v_mfma_f32_32x32x16_bf16 v[64:79], v[152:155], v[148:151], v[64:79]
    v_add_u32 v4, s61, v4
    v_add_u32 v6, s63, v6
    v_fmac_f32 v10, v14, v14
    v_fmac_f32 v11, v15, v15
    ds_read_b64_tr_b16 v[198:199], v7 offset:12800
    ds_read_b64_tr_b16 v[200:201], v7 offset:20480
    ds_read_b64_tr_b16 v[202:203], v7 offset:20992
    v_mfma_f32_32x32x16_bf16 v[80:95], v[156:159], v[148:151], v[80:95]
    v_and_b32 v14, s65, v131
    v_lshlrev_b32 v15, 16, v131
    v_fmac_f32 v10, v14, v14
    v_fmac_f32 v11, v15, v15
    v_mfma_f32_32x32x16_bf16 v[96:111], v[160:163], v[148:151], v[96:111]
    v_add_u32 v5, s61, v5
    v_add_u32 v7, s63, v7
    s_sub_u32 s58, s58, 1
    s_cmp_lg_u32 s58, 0
    s_waitcnt vmcnt(5) lgkmcnt(0)
    s_cbranch_scc1 ATT_LA_N
    v_lshlrev_b32 v250, 7, v0
    buffer_load_dword v251, v250, s[32:35], s77 offen
    s_mov_b32 s58, 2
ATT_LB_N:
    s_barrier
    v_mfma_f32_16x16x32_bf16 v[20:23], v[24:27], v[172:175], v[20:23]
    v_mfma_f32_32x32x16_bf16 v[64:79], v[172:175], v[168:171], v[64:79]
    ds_read_b128 v[128:131], v4 offset:0
    ds_read_b64_tr_b16 v[132:133], v6 offset:0
    ds_read_b64_tr_b16 v[134:135], v6 offset:512
    v_and_b32 v14, s65, v168
    v_lshlrev_b32 v15, 16, v168
    v_fmac_f32 v10, v14, v14
    v_fmac_f32 v11, v15, v15
    ds_read_b64_tr_b16 v[136:137], v6 offset:8192
    ds_read_b64_tr_b16 v[138:139], v6 offset:8704
    v_mfma_f32_32x32x16_bf16 v[80:95], v[176:179], v[168:171], v[80:95]
    v_and_b32 v14, s65, v169
    v_lshlrev_b32 v15, 16, v169
    v_fmac_f32 v10, v14, v14
    v_fmac_f32 v11, v15, v15
    ds_read_b64_tr_b16 v[140:141], v6 offset:16384
    ds_read_b64_tr_b16 v[142:143], v6 offset:16896
    v_mfma_f32_32x32x16_bf16 v[96:111], v[180:183], v[168:171], v[96:111]
    v_and_b32 v14, s65, v170
    v_lshlrev_b32 v15, 16, v170
    ds_read_b128 v[148:151], v5 offset:0
    ds_read_b64_tr_b16 v[152:153], v7 offset:0
    ds_read_b64_tr_b16 v[154:155], v7 offset:512
    v_mfma_f32_32x32x16_bf16 v[64:79], v[192:195], v[188:191], v[64:79]
    v_fmac_f32 v10, v14, v14
    v_fmac_f32 v11, v15, v15
    v_and_b32 v14, s65, v171
    v_lshlrev_b32 v15, 16, v171
    ds_read_b64_tr_b16 v[156:157], v7 offset:8192
    ds_read_b64_tr_b16 v[158:159], v7 offset:8704
    v_mfma_f32_32x32x16_bf16 v[80:95], v[196:199], v[188:191], v[80:95]
    v_fmac_f32 v10, v14, v14
    v_fmac_f32 v11, v15, v15
    ds_read_b64_tr_b16 v[160:161], v7 offset:16384
    ds_read_b64_tr_b16 v[162:163], v7 offset:16896
    v_mfma_f32_32x32x16_bf16 v[96:111], v[200:203], v[188:191], v[96:111]
    s_cmp_eq_u32 s60, 2
    s_cselect_b32 s50, -2, 1
    s_mul_i32 s61, s50, 16384
    s_mul_i32 s62, s50, 3072
    s_mul_i32 s63, s50, 24576
    s_add_u32 s60, s60, 1
    s_cmp_eq_u32 s60, 3
    s_cselect_b32 s60, 0, s60
    ds_read_b128 v[168:171], v4 offset:512
    ds_read_b64_tr_b16 v[172:173], v6 offset:4096
    ds_read_b64_tr_b16 v[174:175], v6 offset:4608
    s_waitcnt lgkmcnt(10)
    v_mfma_f32_16x16x32_bf16 v[20:23], v[24:27], v[132:135], v[20:23]
    v_mfma_f32_32x32x16_bf16 v[64:79], v[132:135], v[128:131], v[64:79]
    v_and_b32 v14, s65, v128
    v_lshlrev_b32 v15, 16, v128
    v_fmac_f32 v10, v14, v14
    v_fmac_f32 v11, v15, v15
    ds_read_b64_tr_b16 v[176:177], v6 offset:12288
    ds_read_b64_tr_b16 v[178:179], v6 offset:12800
    v_mfma_f32_32x32x16_bf16 v[80:95], v[136:139], v[128:131], v[80:95]
    v_and_b32 v14, s65, v129
    v_lshlrev_b32 v15, 16, v129
    v_fmac_f32 v10, v14, v14
    v_fmac_f32 v11, v15, v15
    ds_read_b64_tr_b16 v[180:181], v6 offset:20480
    ds_read_b64_tr_b16 v[182:183], v6 offset:20992
    v_mfma_f32_32x32x16_bf16 v[96:111], v[140:143], v[128:131], v[96:111]
    v_and_b32 v14, s65, v130
    v_lshlrev_b32 v15, 16, v130
    ds_read_b128 v[188:191], v5 offset:512
    ds_read_b64_tr_b16 v[192:193], v7 offset:4096
    ds_read_b64_tr_b16 v[194:195], v7 offset:4608
    ds_read_b64_tr_b16 v[196:197], v7 offset:12288
    s_waitcnt lgkmcnt(11)
    v_mfma_f32_32x32x16_bf16 v[64:79], v[152:155], v[148:151], v[64:79]
    v_add_u32 v4, s61, v4
    v_add_u32 v6, s63, v6
    v_fmac_f32 v10, v14, v14
    v_fmac_f32 v11, v15, v15
    ds_read_b64_tr_b16 v[198:199], v7 offset:12800
    ds_read_b64_tr_b16 v[200:201], v7 offset:20480
    ds_read_b64_tr_b16 v[202:203], v7 offset:20992
    v_mfma_f32_32x32x16_bf16 v[80:95], v[156:159], v[148:151], v[80:95]
    v_and_b32 v14, s65, v131
    v_lshlrev_b32 v15, 16, v131
    v_fmac_f32 v10, v14, v14
    v_fmac_f32 v11, v15, v15
    v_mfma_f32_32x32x16_bf16 v[96:111], v[160:163], v[148:151], v[96:111]
    v_add_u32 v5, s61, v5
    v_add_u32 v7, s63, v7
    s_sub_u32 s58, s58, 1
    s_cmp_eq_u32 s58, 0
    s_cbranch_scc1 ATT_LX_N
    s_waitcnt vmcnt(1) lgkmcnt(0)
    v_lshlrev_b32 v250, 7, v0
    buffer_load_dword v251, v250, s[32:35], s79 offen
    s_branch ATT_LB_N
ATT_LX_N:
    s_waitcnt lgkmcnt(0)
    v_mfma_f32_16x16x32_bf16 v[20:23], v[24:27], v[172:175], v[20:23]
    v_mfma_f32_32x32x16_bf16 v[64:79], v[172:175], v[168:171], v[64:79]
    v_and_b32 v14, s65, v168
    v_lshlrev_b32 v15, 16, v168
    v_fmac_f32 v10, v14, v14
    v_fmac_f32 v11, v15, v15
    v_and_b32 v14, s65, v169
    v_lshlrev_b32 v15, 16, v169
    v_fmac_f32 v10, v14, v14
    v_fmac_f32 v11, v15, v15
    v_mfma_f32_32x32x16_bf16 v[64:79], v[192:195], v[188:191], v[64:79]
    v_and_b32 v14, s65, v170
    v_lshlrev_b32 v15, 16, v170
    v_fmac_f32 v10, v14, v14
    v_fmac_f32 v11, v15, v15
    v_and_b32 v14, s65, v171
    v_lshlrev_b32 v15, 16, v171
    v_fmac_f32 v10, v14, v14
    v_fmac_f32 v11, v15, v15
    v_mfma_f32_32x32x16_bf16 v[80:95], v[176:179], v[168:171], v[80:95]
    v_mfma_f32_32x32x16_bf16 v[80:95], v[196:199], v[188:191], v[80:95]
    v_add_f32 v10, v10, v11
    ds_write_b32 v28, v10
    s_mov_b32 exec_hi, 0
    ds_add_f32 v32, v20
    s_mov_b64 exec, -1
    v_mov_b32 v56, v76
    s_nop 1
    v_permlane32_swap_b32 v76, v56
    v_mul_f32 v56, 0xbb124925, v56
    s_waitcnt lgkmcnt(0)
    s_barrier
    ds_read_b128 v[176:179], v29
    ds_read_b128 v[128:131], v33 offset:0
    ds_read_b128 v[132:135], v33 offset:16
    ds_read_b128 v[136:139], v33 offset:32
    ds_read_b128 v[140:143], v33 offset:48
    v_mfma_f32_32x32x16_bf16 v[96:111], v[180:183], v[168:171], v[96:111]
    v_mfma_f32_32x32x16_bf16 v[96:111], v[200:203], v[188:191], v[96:111]
    ds_read_b128 v[144:147], v33 offset:128
    ds_read_b128 v[148:151], v33 offset:144
    ds_read_b128 v[152:155], v33 offset:160
    ds_read_b128 v[156:159], v33 offset:176
    ds_read_b128 v[160:163], v33 offset:256
    ds_read_b128 v[164:167], v33 offset:272
    ds_read_b128 v[168:171], v33 offset:288
    ds_read_b128 v[172:175], v33 offset:304
    s_waitcnt lgkmcnt(8)
    v_pk_add_f32 v[176:177], v[176:177], v[178:179]
    v_add_f32 v14, v176, v177
    v_mul_f32 v14, 0x3b124925, v14
    v_fma_f32 v14, -v56, v56, v14
    v_max_f32 v14, 0, v14
    v_add_f32 v14, 0x3727c5ac, v14
    v_rsq_f32 v14, v14
    s_nop 0
    v_mov_b32 v60, v14
    v_mul_f32 v62, 0x3e8b97f6, v14
    v_pk_fma_f32 v[64:65], v[128:129], v[56:57], v[64:65] op_sel_hi:[1,0,1]
    v_pk_fma_f32 v[66:67], v[130:131], v[56:57], v[66:67] op_sel_hi:[1,0,1]
    v_pk_fma_f32 v[68:69], v[132:133], v[56:57], v[68:69] op_sel_hi:[1,0,1]
    v_pk_fma_f32 v[70:71], v[134:135], v[56:57], v[70:71] op_sel_hi:[1,0,1]
    v_pk_fma_f32 v[72:73], v[136:137], v[56:57], v[72:73] op_sel_hi:[1,0,1]
    v_pk_fma_f32 v[74:75], v[138:139], v[56:57], v[74:75] op_sel_hi:[1,0,1]
    v_pk_fma_f32 v[76:77], v[140:141], v[56:57], v[76:77] op_sel_hi:[1,0,1]
    v_pk_fma_f32 v[78:79], v[142:143], v[56:57], v[78:79] op_sel_hi:[1,0,1]
    v_pk_mul_f32 v[64:65], v[64:65], v[62:63] op_sel_hi:[1,0]
    v_pk_mul_f32 v[66:67], v[66:67], v[62:63] op_sel_hi:[1,0]
    v_pk_mul_f32 v[68:69], v[68:69], v[62:63] op_sel_hi:[1,0]
    v_pk_mul_f32 v[70:71], v[70:71], v[62:63] op_sel_hi:[1,0]
    v_pk_mul_f32 v[72:73], v[72:73], v[62:63] op_sel_hi:[1,0]
    v_pk_mul_f32 v[74:75], v[74:75], v[62:63] op_sel_hi:[1,0]
    v_pk_mul_f32 v[76:77], v[76:77], v[62:63] op_sel_hi:[1,0]
    v_pk_mul_f32 v[78:79], v[78:79], v[62:63] op_sel_hi:[1,0]
    v_cvt_pk_bf16_f32 v188, v64, v65
    v_cvt_pk_bf16_f32 v189, v66, v67
    v_cvt_pk_bf16_f32 v190, v68, v69
    v_cvt_pk_bf16_f32 v191, v70, v71
    v_cvt_pk_bf16_f32 v192, v72, v73
    v_cvt_pk_bf16_f32 v193, v74, v75
    v_cvt_pk_bf16_f32 v194, v76, v77
    v_cvt_pk_bf16_f32 v195, v78, v79
    v_cndmask_b32 v194, 0, v194, s[68:69]
    v_cndmask_b32 v195, 0, v195, s[68:69]
    ds_write_b128 v34, v[188:191] offset:0
    ds_write_b128 v35, v[192:195] offset:0
    s_waitcnt lgkmcnt(6)
    v_pk_fma_f32 v[80:81], v[144:145], v[56:57], v[80:81] op_sel_hi:[1,0,1]
    v_pk_fma_f32 v[82:83], v[146:147], v[56:57], v[82:83] op_sel_hi:[1,0,1]
    v_pk_fma_f32 v[84:85], v[148:149], v[56:57], v[84:85] op_sel_hi:[1,0,1]
    v_pk_fma_f32 v[86:87], v[150:151], v[56:57], v[86:87] op_sel_hi:[1,0,1]
    v_pk_fma_f32 v[88:89], v[152:153], v[56:57], v[88:89] op_sel_hi:[1,0,1]
    v_pk_fma_f32 v[90:91], v[154:155], v[56:57], v[90:91] op_sel_hi:[1,0,1]
    v_pk_fma_f32 v[92:93], v[156:157], v[56:57], v[92:93] op_sel_hi:[1,0,1]
    v_pk_fma_f32 v[94:95], v[158:159], v[56:57], v[94:95] op_sel_hi:[1,0,1]
    v_pk_mul_f32 v[80:81], v[80:81], v[60:61] op_sel_hi:[1,0]
    v_pk_mul_f32 v[82:83], v[82:83], v[60:61] op_sel_hi:[1,0]
    v_pk_mul_f32 v[84:85], v[84:85], v[60:61] op_sel_hi:[1,0]
    v_pk_mul_f32 v[86:87], v[86:87], v[60:61] op_sel_hi:[1,0]
    v_pk_mul_f32 v[88:89], v[88:89], v[60:61] op_sel_hi:[1,0]
    v_pk_mul_f32 v[90:91], v[90:91], v[60:61] op_sel_hi:[1,0]
    v_pk_mul_f32 v[92:93], v[92:93], v[60:61] op_sel_hi:[1,0]
    v_pk_mul_f32 v[94:95], v[94:95], v[60:61] op_sel_hi:[1,0]
    v_cvt_pk_bf16_f32 v196, v80, v81
    v_cvt_pk_bf16_f32 v197, v82, v83
    v_cvt_pk_bf16_f32 v198, v84, v85
    v_cvt_pk_bf16_f32 v199, v86, v87
    v_cvt_pk_bf16_f32 v200, v88, v89
    v_cvt_pk_bf16_f32 v201, v90, v91
    v_cvt_pk_bf16_f32 v202, v92, v93
    v_cvt_pk_bf16_f32 v203, v94, v95
    ds_write_b128 v34, v[196:199] offset:10240
    ds_write_b128 v35, v[200:203] offset:10240
    s_waitcnt lgkmcnt(4)
    v_pk_fma_f32 v[96:97], v[160:161], v[56:57], v[96:97] op_sel_hi:[1,0,1]
    v_pk_fma_f32 v[98:99], v[162:163], v[56:57], v[98:99] op_sel_hi:[1,0,1]
    v_pk_fma_f32 v[100:101], v[164:165], v[56:57], v[100:101] op_sel_hi:[1,0,1]
    v_pk_fma_f32 v[102:103], v[166:167], v[56:57], v[102:103] op_sel_hi:[1,0,1]
    v_pk_fma_f32 v[104:105], v[168:169], v[56:57], v[104:105] op_sel_hi:[1,0,1]
    v_pk_fma_f32 v[106:107], v[170:171], v[56:57], v[106:107] op_sel_hi:[1,0,1]
    v_pk_fma_f32 v[108:109], v[172:173], v[56:57], v[108:109] op_sel_hi:[1,0,1]
    v_pk_fma_f32 v[110:111], v[174:175], v[56:57], v[110:111] op_sel_hi:[1,0,1]
    v_pk_mul_f32 v[96:97], v[96:97], v[60:61] op_sel_hi:[1,0]
    v_pk_mul_f32 v[98:99], v[98:99], v[60:61] op_sel_hi:[1,0]
    v_pk_mul_f32 v[100:101], v[100:101], v[60:61] op_sel_hi:[1,0]
    v_pk_mul_f32 v[102:103], v[102:103], v[60:61] op_sel_hi:[1,0]
    v_pk_mul_f32 v[104:105], v[104:105], v[60:61] op_sel_hi:[1,0]
    v_pk_mul_f32 v[106:107], v[106:107], v[60:61] op_sel_hi:[1,0]
    v_pk_mul_f32 v[108:109], v[108:109], v[60:61] op_sel_hi:[1,0]
    v_pk_mul_f32 v[110:111], v[110:111], v[60:61] op_sel_hi:[1,0]
    v_cvt_pk_bf16_f32 v188, v96, v97
    v_cvt_pk_bf16_f32 v189, v98, v99
    v_cvt_pk_bf16_f32 v190, v100, v101
    v_cvt_pk_bf16_f32 v191, v102, v103
    v_cvt_pk_bf16_f32 v192, v104, v105
    v_cvt_pk_bf16_f32 v193, v106, v107
    v_cvt_pk_bf16_f32 v194, v108, v109
    v_cvt_pk_bf16_f32 v195, v110, v111
    ds_write_b128 v34, v[188:191] offset:20480
    ds_write_b128 v35, v[192:195] offset:20480
    s_cmp_lt_u32 s3, 4
    s_cbranch_scc1 P2_EP1A
    s_branch P2_EP1B
P2_EP1A:
    s_add_u32 m0, s91, 16384
    s_nop 0
    buffer_load_dwordx4 v252, s[92:95], s90 offen lds
    buffer_load_dwordx4 v253, s[92:95], s90 offen offset:1024 lds
    s_add_u32 s90, s90, 14336
    s_add_u32 m0, s91, 32768
    s_nop 0
    buffer_load_dwordx4 v252, s[92:95], s90 offen lds
    buffer_load_dwordx4 v254, s[92:95], s90 offen offset:1024 lds
    s_add_u32 s90, s90, s96
    s_add_u32 m0, s91, 114688
    s_nop 0
    buffer_load_dwordx4 v252, s[92:95], s90 offen lds
    buffer_load_dwordx4 v253, s[92:95], s90 offen offset:1024 lds
    s_add_u32 s90, s90, 14336
    s_add_u32 m0, s91, 131072
    s_nop 0
    buffer_load_dwordx4 v252, s[92:95], s90 offen lds
    buffer_load_dwordx4 v254, s[92:95], s90 offen offset:1024 lds
    s_add_u32 s90, s90, s96
    s_add_u32 m0, s91, 0
    s_nop 0
    buffer_load_dwordx4 v252, s[92:95], s90 offen lds
    buffer_load_dwordx4 v253, s[92:95], s90 offen offset:1024 lds
    s_add_u32 s90, s90, 14336
P2_EP1B:
    s_branch ATT_POST
ATT_K:
    s_waitcnt vmcnt(7) lgkmcnt(0)
    s_barrier
    ds_read_b128 v[128:131], v4 offset:0
    ds_read_b64_tr_b16 v[132:133], v6 offset:0
    ds_read_b64_tr_b16 v[134:135], v6 offset:512
    s_add_u32 m0, s53, 0
    s_nop 0
    buffer_load_dwordx4 v1, s[20:23], s52 offen lds
    ds_read_b64_tr_b16 v[136:137], v6 offset:8192
    ds_read_b64_tr_b16 v[138:139], v6 offset:8704
    ds_read_b64_tr_b16 v[140:141], v6 offset:16384
    ds_read_b64_tr_b16 v[142:143], v6 offset:16896
    s_add_u32 m0, s53, 1024
    s_add_u32 s49, s52, 896
    buffer_load_dwordx4 v1, s[20:23], s49 offen lds
    ds_read_b128 v[144:147], v8 offset:0
    ds_read_b128 v[148:151], v5 offset:0
    ds_read_b64_tr_b16 v[152:153], v7 offset:0
    ds_read_b64_tr_b16 v[154:155], v7 offset:512
    s_mov_b32 m0, s55
    s_nop 0
    buffer_load_dwordx4 v1, s[20:23], s54 offen lds
    ds_read_b64_tr_b16 v[156:157], v7 offset:8192
    ds_read_b64_tr_b16 v[158:159], v7 offset:8704
    ds_read_b64_tr_b16 v[160:161], v7 offset:16384
    ds_read_b64_tr_b16 v[162:163], v7 offset:16896
    s_add_u32 m0, s57, 0
    s_mov_b64 exec, s[66:67]
    buffer_load_dwordx4 v2, s[24:27], s56 offen lds
    s_mov_b64 exec, -1
    ds_read_b128 v[164:167], v9 offset:0
    s_cmp_eq_u32 s60, 2
    s_cselect_b32 s50, -2, 1
    s_mul_i32 s61, s50, 16384
    s_mul_i32 s62, s50, 3072
    s_mul_i32 s63, s50, 24576
    s_add_u32 s60, s60, 1
    s_cmp_eq_u32 s60, 3
    s_cselect_b32 s60, 0, s60
    ds_read_b128 v[168:171], v4 offset:512
    ds_read_b64_tr_b16 v[172:173], v6 offset:4096
    ds_read_b64_tr_b16 v[174:175], v6 offset:4608
    s_waitcnt lgkmcnt(11)
    v_mfma_f32_32x32x16_bf16 v[64:79], v[132:135], v[128:131], 0
    s_add_u32 m0, s57, 8192
    s_add_u32 s49, s56, 896
    s_mov_b64 exec, s[66:67]
    buffer_load_dwordx4 v2, s[24:27], s49 offen lds
    s_mov_b64 exec, -1
    v_and_b32 v18, s65, v144
    v_lshlrev_b32 v19, 16, v144
    ds_read_b64_tr_b16 v[176:177], v6 offset:12288
    ds_read_b64_tr_b16 v[178:179], v6 offset:12800
    v_mfma_f32_32x32x16_bf16 v[80:95], v[136:139], v[128:131], 0
    v_fmac_f32 v12, v18, v18
    v_fmac_f32 v13, v19, v19
    v_and_b32 v18, s65, v145
    v_lshlrev_b32 v19, 16, v145
    ds_read_b64_tr_b16 v[180:181], v6 offset:20480
    ds_read_b64_tr_b16 v[182:183], v6 offset:20992
    v_mfma_f32_32x32x16_bf16 v[96:111], v[140:143], v[128:131], 0
    s_add_u32 m0, s57, 16384
    s_add_u32 s49, s56, 1792
    s_mov_b64 exec, s[66:67]
    buffer_load_dwordx4 v2, s[24:27], s49 offen lds
    s_mov_b64 exec, -1
    s_add_u32 s52, s52, 128
    s_add_u32 s54, s54, 128
    s_add_u32 s56, s56, 172032
    s_cmp_eq_u32 s59, 2
    s_cselect_b32 s50, -2, 1
    s_mul_i32 s49, s50, 16384
    s_add_u32 s53, s53, s49
    s_mul_i32 s49, s50, 3072
    s_add_u32 s55, s55, s49
    s_mul_i32 s49, s50, 24576
    s_add_u32 s57, s57, s49
    s_add_u32 s59, s59, 1
    s_cmp_eq_u32 s59, 3
    s_cselect_b32 s59, 0, s59
    v_fmac_f32 v12, v18, v18
    v_fmac_f32 v13, v19, v19
    ds_read_b128 v[184:187], v8 offset:512
    v_mfma_f32_32x32x16_bf16 v[112:127], v[136:139], v[144:147], 0
    v_and_b32 v18, s65, v146
    v_lshlrev_b32 v19, 16, v146
    v_fmac_f32 v12, v18, v18
    v_fmac_f32 v13, v19, v19
    ds_read_b128 v[188:191], v5 offset:512
    ds_read_b64_tr_b16 v[192:193], v7 offset:4096
    ds_read_b64_tr_b16 v[194:195], v7 offset:4608
    s_waitcnt lgkmcnt(11)
    v_mfma_f32_32x32x16_bf16 v[64:79], v[152:155], v[148:151], v[64:79]
    v_add_u32 v4, s61, v4
    v_add_u32 v6, s63, v6
    v_add_u32 v8, s62, v8
    v_and_b32 v14, s65, v148
    ds_read_b64_tr_b16 v[196:197], v7 offset:12288
    ds_read_b64_tr_b16 v[198:199], v7 offset:12800
    ds_read_b128 v[204:207], v9 offset:512
    v_mfma_f32_32x32x16_bf16 v[80:95], v[156:159], v[148:151], v[80:95]
    v_lshlrev_b32 v15, 16, v148
    v_fmac_f32 v10, v14, v14
    v_fmac_f32 v11, v15, v15
    v_and_b32 v14, s65, v149
    ds_read_b64_tr_b16 v[200:201], v7 offset:20480
    ds_read_b64_tr_b16 v[202:203], v7 offset:20992
    v_mfma_f32_32x32x16_bf16 v[96:111], v[160:163], v[148:151], v[96:111]
    v_lshlrev_b32 v15, 16, v149
    v_fmac_f32 v10, v14, v14
    v_fmac_f32 v11, v15, v15
    v_and_b32 v14, s65, v150
    v_mfma_f32_32x32x16_bf16 v[112:127], v[156:159], v[164:167], v[112:127]
    v_add_u32 v5, s61, v5
    v_add_u32 v7, s63, v7
    v_add_u32 v9, s62, v9
    v_lshlrev_b32 v15, 16, v150
    s_lshr_b32 s49, s2, 3
    s_mul_i32 s97, s49, 37
    s_lshr_b32 s97, s97, 8
    s_mul_i32 s50, s97, 7
    s_sub_u32 s98, s49, s50
    s_and_b32 s49, s2, 7
    s_lshl_b32 s49, s49, 2
    s_add_u32 s97, s97, s49
    s_mov_b32 s91, s3
    s_sub_u32 s49, s91, 2
    s_mul_i32 s99, s49, 19
    s_cmp_eq_u32 s91, 7
    s_cselect_b32 s99, 94, s99
    s_mul_i32 s49, s91, 200704
    s_mul_i32 s50, s99, 14336
    s_cmp_lt_u32 s91, 2
    s_cselect_b32 s90, s49, s50
    s_cselect_b32 s92, s8, s10
    s_cselect_b32 s93, s9, s11
    s_mov_b32 s94, 1605632
    s_cselect_b32 s94, 401408, s94
    s_mov_b32 s95, 0x20000
    s_mov_b32 s96, 14336
    s_cselect_b32 s96, 10752, s96
    s_mov_b32 s49, 6144
    s_cselect_b32 s49, 2560, s49
    s_cselect_b32 s50, 1073741824, 0
    s_cselect_b64 vcc, -1, 0
    v_lshrrev_b32 v240, 3, v0
    v_and_b32 v241, 7, v0
    v_bfe_u32 v242, v0, 4, 1
    v_lshlrev_b32 v242, 2, v242
    v_xor_b32 v242, v242, v241
    v_lshrrev_b32 v243, 2, v240
    v_and_b32 v244, 3, v240
    v_lshl_add_u32 v244, v243, 3, v244
    v_cndmask_b32 v240, v240, v244, vcc
    v_mul_u32_u24 v240, 896, v240
    v_lshl_add_u32 v252, v242, 4, v240
    v_add_u32 v253, s49, v252
    v_mul_lo_u32 v243, v243, s50
    v_add_u32 v254, v253, v243
    s_lshl_b32 s49, s98, 7
    s_add_u32 s90, s90, s49
    s_lshl_b32 s91, s91, 11
    s_mov_b32 s58, 4
    s_waitcnt vmcnt(6) lgkmcnt(0)
ATT_LA_K:
    s_barrier
    v_mfma_f32_32x32x16_bf16 v[64:79], v[172:175], v[168:171], v[64:79]
    s_add_u32 m0, s53, 0
    s_nop 0
    buffer_load_dwordx4 v1, s[20:23], s52 offen lds
    ds_read_b128 v[128:131], v4 offset:0
    ds_read_b64_tr_b16 v[132:133], v6 offset:0
    ds_read_b64_tr_b16 v[134:135], v6 offset:512
    v_fmac_f32 v10, v14, v14
    v_fmac_f32 v11, v15, v15
    ds_read_b64_tr_b16 v[136:137], v6 offset:8192
    ds_read_b64_tr_b16 v[138:139], v6 offset:8704
    v_mfma_f32_32x32x16_bf16 v[80:95], v[176:179], v[168:171], v[80:95]
    v_and_b32 v14, s65, v151
    v_lshlrev_b32 v15, 16, v151
    v_fmac_f32 v10, v14, v14
    v_fmac_f32 v11, v15, v15
    ds_read_b64_tr_b16 v[140:141], v6 offset:16384
    ds_read_b64_tr_b16 v[142:143], v6 offset:16896
    v_mfma_f32_32x32x16_bf16 v[96:111], v[180:183], v[168:171], v[96:111]
    s_add_u32 m0, s53, 1024
    s_add_u32 s49, s52, 896
    buffer_load_dwordx4 v1, s[20:23], s49 offen lds
    v_and_b32 v18, s65, v147
    v_lshlrev_b32 v19, 16, v147
    v_fmac_f32 v12, v18, v18
    v_fmac_f32 v13, v19, v19
    ds_read_b128 v[144:147], v8 offset:0
    v_mfma_f32_32x32x16_bf16 v[112:127], v[176:179], v[184:187], v[112:127]
    v_and_b32 v16, s65, v188
    v_lshlrev_b32 v17, 16, v188
    v_fmac_f32 v10, v16, v16
    v_fmac_f32 v11, v17, v17
    ds_read_b128 v[148:151], v5 offset:0
    ds_read_b64_tr_b16 v[152:153], v7 offset:0
    ds_read_b64_tr_b16 v[154:155], v7 offset:512
    v_mfma_f32_32x32x16_bf16 v[64:79], v[192:195], v[188:191], v[64:79]
    s_mov_b32 m0, s55
    s_nop 0
    buffer_load_dwordx4 v1, s[20:23], s54 offen lds
    v_and_b32 v16, s65, v189
    v_lshlrev_b32 v17, 16, v189
    ds_read_b64_tr_b16 v[156:157], v7 offset:8192
    ds_read_b64_tr_b16 v[158:159], v7 offset:8704
    v_mfma_f32_32x32x16_bf16 v[80:95], v[196:199], v[188:191], v[80:95]
    v_fmac_f32 v10, v16, v16
    v_fmac_f32 v11, v17, v17
    v_and_b32 v16, s65, v190
    v_lshlrev_b32 v17, 16, v190
    ds_read_b64_tr_b16 v[160:161], v7 offset:16384
    ds_read_b64_tr_b16 v[162:163], v7 offset:16896
    v_mfma_f32_32x32x16_bf16 v[96:111], v[200:203], v[188:191], v[96:111]
    s_add_u32 m0, s57, 0
    s_mov_b64 exec, s[66:67]
    buffer_load_dwordx4 v2, s[24:27], s56 offen lds
    s_mov_b64 exec, -1
    v_fmac_f32 v10, v16, v16
    v_fmac_f32 v11, v17, v17
    ds_read_b128 v[164:167], v9 offset:0
    v_mfma_f32_32x32x16_bf16 v[112:127], v[196:199], v[204:207], v[112:127]
    v_and_b32 v16, s65, v191
    v_lshlrev_b32 v17, 16, v191
    v_fmac_f32 v10, v16, v16
    v_fmac_f32 v11, v17, v17
    s_cmp_eq_u32 s60, 2
    s_cselect_b32 s50, -2, 1
    s_mul_i32 s61, s50, 16384
    s_mul_i32 s62, s50, 3072
    s_mul_i32 s63, s50, 24576
    s_add_u32 s60, s60, 1
    s_cmp_eq_u32 s60, 3
    s_cselect_b32 s60, 0, s60
    ds_read_b128 v[168:171], v4 offset:512
    ds_read_b64_tr_b16 v[172:173], v6 offset:4096
    ds_read_b64_tr_b16 v[174:175], v6 offset:4608
    s_waitcnt lgkmcnt(11)
    v_mfma_f32_32x32x16_bf16 v[64:79], v[132:135], v[128:131], v[64:79]
    s_add_u32 m0, s57, 8192
    s_add_u32 s49, s56, 896
    s_mov_b64 exec, s[66:67]
    buffer_load_dwordx4 v2, s[24:27], s49 offen lds
    s_mov_b64 exec, -1
    v_and_b32 v18, s65, v144
    v_lshlrev_b32 v19, 16, v144
    ds_read_b64_tr_b16 v[176:177], v6 offset:12288
    ds_read_b64_tr_b16 v[178:179], v6 offset:12800
    v_mfma_f32_32x32x16_bf16 v[80:95], v[136:139], v[128:131], v[80:95]
    v_fmac_f32 v12, v18, v18
    v_fmac_f32 v13, v19, v19
    v_and_b32 v18, s65, v145
    v_lshlrev_b32 v19, 16, v145
    ds_read_b64_tr_b16 v[180:181], v6 offset:20480
    ds_read_b64_tr_b16 v[182:183], v6 offset:20992
    v_mfma_f32_32x32x16_bf16 v[96:111], v[140:143], v[128:131], v[96:111]
    s_add_u32 m0, s57, 16384
    s_add_u32 s49, s56, 1792
    s_mov_b64 exec, s[66:67]
    buffer_load_dwordx4 v2, s[24:27], s49 offen lds
    s_mov_b64 exec, -1
    s_add_u32 s52, s52, 128
    s_add_u32 s54, s54, 128
    s_add_u32 s56, s56, 172032
    s_cmp_eq_u32 s59, 2
    s_cselect_b32 s50, -2, 1
    s_mul_i32 s49, s50, 16384
    s_add_u32 s53, s53, s49
    s_mul_i32 s49, s50, 3072
    s_add_u32 s55, s55, s49
    s_mul_i32 s49, s50, 24576
    s_add_u32 s57, s57, s49
    s_add_u32 s59, s59, 1
    s_cmp_eq_u32 s59, 3
    s_cselect_b32 s59, 0, s59
    v_fmac_f32 v12, v18, v18
    v_fmac_f32 v13, v19, v19
    ds_read_b128 v[184:187], v8 offset:512
    v_mfma_f32_32x32x16_bf16 v[112:127], v[136:139], v[144:147], v[112:127]
    v_and_b32 v18, s65, v146
    v_lshlrev_b32 v19, 16, v146
    v_fmac_f32 v12, v18, v18
    v_fmac_f32 v13, v19, v19
    ds_read_b128 v[188:191], v5 offset:512
    ds_read_b64_tr_b16 v[192:193], v7 offset:4096
    ds_read_b64_tr_b16 v[194:195], v7 offset:4608
    s_waitcnt lgkmcnt(11)
    v_mfma_f32_32x32x16_bf16 v[64:79], v[152:155], v[148:151], v[64:79]
    v_add_u32 v4, s61, v4
    v_add_u32 v6, s63, v6
    v_add_u32 v8, s62, v8
    v_and_b32 v14, s65, v148
    ds_read_b64_tr_b16 v[196:197], v7 offset:12288
    ds_read_b64_tr_b16 v[198:199], v7 offset:12800
    ds_read_b128 v[204:207], v9 offset:512
    v_mfma_f32_32x32x16_bf16 v[80:95], v[156:159], v[148:151], v[80:95]
    v_lshlrev_b32 v15, 16, v148
    v_fmac_f32 v10, v14, v14
    v_fmac_f32 v11, v15, v15
    v_and_b32 v14, s65, v149
    ds_read_b64_tr_b16 v[200:201], v7 offset:20480
    ds_read_b64_tr_b16 v[202:203], v7 offset:20992
    v_mfma_f32_32x32x16_bf16 v[96:111], v[160:163], v[148:151], v[96:111]
    v_lshlrev_b32 v15, 16, v149
    v_fmac_f32 v10, v14, v14
    v_fmac_f32 v11, v15, v15
    v_and_b32 v14, s65, v150
    v_mfma_f32_32x32x16_bf16 v[112:127], v[156:159], v[164:167], v[112:127]
    v_add_u32 v5, s61, v5
    v_add_u32 v7, s63, v7
    v_add_u32 v9, s62, v9
    v_lshlrev_b32 v15, 16, v150
    s_sub_u32 s58, s58, 1
    s_cmp_lg_u32 s58, 0
    s_waitcnt vmcnt(6) lgkmcnt(0)
    s_cbranch_scc1 ATT_LA_K
    v_lshlrev_b32 v250, 7, v0
    buffer_load_dword v251, v250, s[32:35], s77 offen
    s_mov_b32 s58, 2
ATT_LB_K:
    s_barrier
    v_mfma_f32_32x32x16_bf16 v[64:79], v[172:175], v[168:171], v[64:79]
    ds_read_b128 v[128:131], v4 offset:0
    ds_read_b64_tr_b16 v[132:133], v6 offset:0
    ds_read_b64_tr_b16 v[134:135], v6 offset:512
    v_fmac_f32 v10, v14, v14
    v_fmac_f32 v11, v15, v15
    ds_read_b64_tr_b16 v[136:137], v6 offset:8192
    ds_read_b64_tr_b16 v[138:139], v6 offset:8704
    v_mfma_f32_32x32x16_bf16 v[80:95], v[176:179], v[168:171], v[80:95]
    v_and_b32 v14, s65, v151
    v_lshlrev_b32 v15, 16, v151
    v_fmac_f32 v10, v14, v14
    v_fmac_f32 v11, v15, v15
    ds_read_b64_tr_b16 v[140:141], v6 offset:16384
    ds_read_b64_tr_b16 v[142:143], v6 offset:16896
    v_mfma_f32_32x32x16_bf16 v[96:111], v[180:183], v[168:171], v[96:111]
    v_and_b32 v18, s65, v147
    v_lshlrev_b32 v19, 16, v147
    v_fmac_f32 v12, v18, v18
    v_fmac_f32 v13, v19, v19
    ds_read_b128 v[144:147], v8 offset:0
    v_mfma_f32_32x32x16_bf16 v[112:127], v[176:179], v[184:187], v[112:127]
    v_and_b32 v16, s65, v188
    v_lshlrev_b32 v17, 16, v188
    v_fmac_f32 v10, v16, v16
    v_fmac_f32 v11, v17, v17
    ds_read_b128 v[148:151], v5 offset:0
    ds_read_b64_tr_b16 v[152:153], v7 offset:0
    ds_read_b64_tr_b16 v[154:155], v7 offset:512
    v_mfma_f32_32x32x16_bf16 v[64:79], v[192:195], v[188:191], v[64:79]
    v_and_b32 v16, s65, v189
    v_lshlrev_b32 v17, 16, v189
    ds_read_b64_tr_b16 v[156:157], v7 offset:8192
    ds_read_b64_tr_b16 v[158:159], v7 offset:8704
    v_mfma_f32_32x32x16_bf16 v[80:95], v[196:199], v[188:191], v[80:95]
    v_fmac_f32 v10, v16, v16
    v_fmac_f32 v11, v17, v17
    v_and_b32 v16, s65, v190
    v_lshlrev_b32 v17, 16, v190
    ds_read_b64_tr_b16 v[160:161], v7 offset:16384
    ds_read_b64_tr_b16 v[162:163], v7 offset:16896
    v_mfma_f32_32x32x16_bf16 v[96:111], v[200:203], v[188:191], v[96:111]
    v_fmac_f32 v10, v16, v16
    v_fmac_f32 v11, v17, v17
    ds_read_b128 v[164:167], v9 offset:0
    v_mfma_f32_32x32x16_bf16 v[112:127], v[196:199], v[204:207], v[112:127]
    v_and_b32 v16, s65, v191
    v_lshlrev_b32 v17, 16, v191
    v_fmac_f32 v10, v16, v16
    v_fmac_f32 v11, v17, v17
    s_cmp_eq_u32 s60, 2
    s_cselect_b32 s50, -2, 1
    s_mul_i32 s61, s50, 16384
    s_mul_i32 s62, s50, 3072
    s_mul_i32 s63, s50, 24576
    s_add_u32 s60, s60, 1
    s_cmp_eq_u32 s60, 3
    s_cselect_b32 s60, 0, s60
    ds_read_b128 v[168:171], v4 offset:512
    ds_read_b64_tr_b16 v[172:173], v6 offset:4096
    ds_read_b64_tr_b16 v[174:175], v6 offset:4608
    s_waitcnt lgkmcnt(11)
    v_mfma_f32_32x32x16_bf16 v[64:79], v[132:135], v[128:131], v[64:79]
    v_and_b32 v18, s65, v144
    v_lshlrev_b32 v19, 16, v144
    ds_read_b64_tr_b16 v[176:177], v6 offset:12288
    ds_read_b64_tr_b16 v[178:179], v6 offset:12800
    v_mfma_f32_32x32x16_bf16 v[80:95], v[136:139], v[128:131], v[80:95]
    v_fmac_f32 v12, v18, v18
    v_fmac_f32 v13, v19, v19
    v_and_b32 v18, s65, v145
    v_lshlrev_b32 v19, 16, v145
    ds_read_b64_tr_b16 v[180:181], v6 offset:20480
    ds_read_b64_tr_b16 v[182:183], v6 offset:20992
    v_mfma_f32_32x32x16_bf16 v[96:111], v[140:143], v[128:131], v[96:111]
    v_fmac_f32 v12, v18, v18
    v_fmac_f32 v13, v19, v19
    ds_read_b128 v[184:187], v8 offset:512
    v_mfma_f32_32x32x16_bf16 v[112:127], v[136:139], v[144:147], v[112:127]
    v_and_b32 v18, s65, v146
    v_lshlrev_b32 v19, 16, v146
    v_fmac_f32 v12, v18, v18
    v_fmac_f32 v13, v19, v19
    ds_read_b128 v[188:191], v5 offset:512
    ds_read_b64_tr_b16 v[192:193], v7 offset:4096
    ds_read_b64_tr_b16 v[194:195], v7 offset:4608
    s_waitcnt lgkmcnt(11)
    v_mfma_f32_32x32x16_bf16 v[64:79], v[152:155], v[148:151], v[64:79]
    v_add_u32 v4, s61, v4
    v_add_u32 v6, s63, v6
    v_add_u32 v8, s62, v8
    v_and_b32 v14, s65, v148
    ds_read_b64_tr_b16 v[196:197], v7 offset:12288
    ds_read_b64_tr_b16 v[198:199], v7 offset:12800
    ds_read_b128 v[204:207], v9 offset:512
    v_mfma_f32_32x32x16_bf16 v[80:95], v[156:159], v[148:151], v[80:95]
    v_lshlrev_b32 v15, 16, v148
    v_fmac_f32 v10, v14, v14
    v_fmac_f32 v11, v15, v15
    v_and_b32 v14, s65, v149
    ds_read_b64_tr_b16 v[200:201], v7 offset:20480
    ds_read_b64_tr_b16 v[202:203], v7 offset:20992
    v_mfma_f32_32x32x16_bf16 v[96:111], v[160:163], v[148:151], v[96:111]
    v_lshlrev_b32 v15, 16, v149
    v_fmac_f32 v10, v14, v14
    v_fmac_f32 v11, v15, v15
    v_and_b32 v14, s65, v150
    v_mfma_f32_32x32x16_bf16 v[112:127], v[156:159], v[164:167], v[112:127]
    v_add_u32 v5, s61, v5
    v_add_u32 v7, s63, v7
    v_add_u32 v9, s62, v9
    v_lshlrev_b32 v15, 16, v150
    s_sub_u32 s58, s58, 1
    s_cmp_eq_u32 s58, 0
    s_cbranch_scc1 ATT_LX_K
    s_waitcnt vmcnt(1) lgkmcnt(0)
    v_lshlrev_b32 v250, 7, v0
    buffer_load_dword v251, v250, s[32:35], s79 offen
    s_branch ATT_LB_K
ATT_LX_K:
    s_waitcnt lgkmcnt(0)
    v_mfma_f32_32x32x16_bf16 v[112:127], v[176:179], v[184:187], v[112:127]
    v_fmac_f32 v10, v14, v14
    v_fmac_f32 v11, v15, v15
    v_and_b32 v14, s65, v151
    v_lshlrev_b32 v15, 16, v151
    v_fmac_f32 v10, v14, v14
    v_fmac_f32 v11, v15, v15
    v_and_b32 v18, s65, v147
    v_lshlrev_b32 v19, 16, v147
    v_mfma_f32_32x32x16_bf16 v[112:127], v[196:199], v[204:207], v[112:127]
    v_fmac_f32 v12, v18, v18
    v_fmac_f32 v13, v19, v19
    v_and_b32 v16, s65, v188
    v_lshlrev_b32 v17, 16, v188
    v_fmac_f32 v10, v16, v16
    v_fmac_f32 v11, v17, v17
    v_and_b32 v16, s65, v189
    v_lshlrev_b32 v17, 16, v189
    v_mfma_f32_32x32x16_bf16 v[64:79], v[172:175], v[168:171], v[64:79]
    v_fmac_f32 v10, v16, v16
    v_fmac_f32 v11, v17, v17
    v_and_b32 v16, s65, v190
    v_lshlrev_b32 v17, 16, v190
    v_fmac_f32 v10, v16, v16
    v_fmac_f32 v11, v17, v17
    v_and_b32 v16, s65, v191
    v_lshlrev_b32 v17, 16, v191
    v_mfma_f32_32x32x16_bf16 v[64:79], v[192:195], v[188:191], v[64:79]
    v_fmac_f32 v10, v16, v16
    v_fmac_f32 v11, v17, v17
    v_mfma_f32_32x32x16_bf16 v[80:95], v[176:179], v[168:171], v[80:95]
    v_mfma_f32_32x32x16_bf16 v[80:95], v[196:199], v[188:191], v[80:95]
    v_add_f32 v10, v10, v11
    ds_write_b32 v28, v10
    v_add_f32 v12, v12, v13
    ds_write_b32 v30, v12
    s_mov_b32 exec_lo, 1
    s_mov_b32 exec_hi, 1
    ds_write_b128 v33, v[112:115] offset:128
    ds_write_b128 v33, v[116:119] offset:144
    ds_write_b128 v33, v[120:123] offset:160
    ds_write_b128 v33, v[124:127] offset:176
    s_mov_b64 exec, -1
    v_mov_b32 v58, v124
    s_nop 1
    v_permlane32_swap_b32 v124, v58
    v_mul_f32 v58, 0xbb124925, v58
    v_mov_b32 v56, v76
    s_nop 1
    v_permlane32_swap_b32 v76, v56
    v_mul_f32 v56, 0xbb124925, v56
    s_waitcnt lgkmcnt(0)
    s_barrier
    ds_read_b128 v[176:179], v29
    ds_read_b128 v[128:131], v33 offset:0
    ds_read_b128 v[132:135], v33 offset:16
    ds_read_b128 v[136:139], v33 offset:32
    ds_read_b128 v[140:143], v33 offset:48
    v_mfma_f32_32x32x16_bf16 v[96:111], v[180:183], v[168:171], v[96:111]
    v_mfma_f32_32x32x16_bf16 v[96:111], v[200:203], v[188:191], v[96:111]
    ds_read_b128 v[144:147], v33 offset:128
    ds_read_b128 v[148:151], v33 offset:144
    ds_read_b128 v[152:155], v33 offset:160
    ds_read_b128 v[156:159], v33 offset:176
    ds_read_b128 v[160:163], v33 offset:256
    ds_read_b128 v[164:167], v33 offset:272
    ds_read_b128 v[168:171], v33 offset:288
    ds_read_b128 v[172:175], v33 offset:304
    ds_read_b128 v[180:183], v31
    ds_read_b128 v[184:187], v31 offset:16
    s_waitcnt lgkmcnt(10)
    v_pk_add_f32 v[176:177], v[176:177], v[178:179]
    v_add_f32 v14, v176, v177
    v_mul_f32 v14, 0x3b124925, v14
    v_fma_f32 v14, -v56, v56, v14
    v_max_f32 v14, 0, v14
    v_add_f32 v14, 0x3727c5ac, v14
    v_rsq_f32 v14, v14
    s_nop 0
    v_mov_b32 v60, v14
    v_mul_f32 v62, 0x3e8b97f6, v14
    v_pk_fma_f32 v[64:65], v[128:129], v[56:57], v[64:65] op_sel_hi:[1,0,1]
    v_pk_fma_f32 v[66:67], v[130:131], v[56:57], v[66:67] op_sel_hi:[1,0,1]
    v_pk_fma_f32 v[68:69], v[132:133], v[56:57], v[68:69] op_sel_hi:[1,0,1]
    v_pk_fma_f32 v[70:71], v[134:135], v[56:57], v[70:71] op_sel_hi:[1,0,1]
    v_pk_fma_f32 v[72:73], v[136:137], v[56:57], v[72:73] op_sel_hi:[1,0,1]
    v_pk_fma_f32 v[74:75], v[138:139], v[56:57], v[74:75] op_sel_hi:[1,0,1]
    v_pk_fma_f32 v[76:77], v[140:141], v[56:57], v[76:77] op_sel_hi:[1,0,1]
    v_pk_fma_f32 v[78:79], v[142:143], v[56:57], v[78:79] op_sel_hi:[1,0,1]
    v_pk_mul_f32 v[64:65], v[64:65], v[62:63] op_sel_hi:[1,0]
    v_pk_mul_f32 v[66:67], v[66:67], v[62:63] op_sel_hi:[1,0]
    v_pk_mul_f32 v[68:69], v[68:69], v[62:63] op_sel_hi:[1,0]
    v_pk_mul_f32 v[70:71], v[70:71], v[62:63] op_sel_hi:[1,0]
    v_pk_mul_f32 v[72:73], v[72:73], v[62:63] op_sel_hi:[1,0]
    v_pk_mul_f32 v[74:75], v[74:75], v[62:63] op_sel_hi:[1,0]
    v_pk_mul_f32 v[76:77], v[76:77], v[62:63] op_sel_hi:[1,0]
    v_pk_mul_f32 v[78:79], v[78:79], v[62:63] op_sel_hi:[1,0]
    v_cvt_pk_bf16_f32 v188, v64, v65
    v_cvt_pk_bf16_f32 v189, v66, v67
    v_cvt_pk_bf16_f32 v190, v68, v69
    v_cvt_pk_bf16_f32 v191, v70, v71
    v_cvt_pk_bf16_f32 v192, v72, v73
    v_cvt_pk_bf16_f32 v193, v74, v75
    v_cvt_pk_bf16_f32 v194, v76, v77
    v_cvt_pk_bf16_f32 v195, v78, v79
    v_cndmask_b32 v194, 0, v194, s[68:69]
    v_cndmask_b32 v195, 0, v195, s[68:69]
    ds_write_b128 v34, v[188:191] offset:0
    ds_write_b128 v35, v[192:195] offset:0
    s_waitcnt lgkmcnt(8)
    v_pk_fma_f32 v[80:81], v[144:145], v[56:57], v[80:81] op_sel_hi:[1,0,1]
    v_pk_fma_f32 v[82:83], v[146:147], v[56:57], v[82:83] op_sel_hi:[1,0,1]
    v_pk_fma_f32 v[84:85], v[148:149], v[56:57], v[84:85] op_sel_hi:[1,0,1]
    v_pk_fma_f32 v[86:87], v[150:151], v[56:57], v[86:87] op_sel_hi:[1,0,1]
    v_pk_fma_f32 v[88:89], v[152:153], v[56:57], v[88:89] op_sel_hi:[1,0,1]
    v_pk_fma_f32 v[90:91], v[154:155], v[56:57], v[90:91] op_sel_hi:[1,0,1]
    v_pk_fma_f32 v[92:93], v[156:157], v[56:57], v[92:93] op_sel_hi:[1,0,1]
    v_pk_fma_f32 v[94:95], v[158:159], v[56:57], v[94:95] op_sel_hi:[1,0,1]
    v_pk_mul_f32 v[80:81], v[80:81], v[60:61] op_sel_hi:[1,0]
    v_pk_mul_f32 v[82:83], v[82:83], v[60:61] op_sel_hi:[1,0]
    v_pk_mul_f32 v[84:85], v[84:85], v[60:61] op_sel_hi:[1,0]
    v_pk_mul_f32 v[86:87], v[86:87], v[60:61] op_sel_hi:[1,0]
    v_pk_mul_f32 v[88:89], v[88:89], v[60:61] op_sel_hi:[1,0]
    v_pk_mul_f32 v[90:91], v[90:91], v[60:61] op_sel_hi:[1,0]
    v_pk_mul_f32 v[92:93], v[92:93], v[60:61] op_sel_hi:[1,0]
    v_pk_mul_f32 v[94:95], v[94:95], v[60:61] op_sel_hi:[1,0]
    v_cvt_pk_bf16_f32 v196, v80, v81
    v_cvt_pk_bf16_f32 v197, v82, v83
    v_cvt_pk_bf16_f32 v198, v84, v85
    v_cvt_pk_bf16_f32 v199, v86, v87
    v_cvt_pk_bf16_f32 v200, v88, v89
    v_cvt_pk_bf16_f32 v201, v90, v91
    v_cvt_pk_bf16_f32 v202, v92, v93
    v_cvt_pk_bf16_f32 v203, v94, v95
    ds_write_b128 v34, v[196:199] offset:10240
    ds_write_b128 v35, v[200:203] offset:10240
    s_waitcnt lgkmcnt(6)
    s_waitcnt lgkmcnt(4)
    v_pk_add_f32 v[180:181], v[180:181], v[184:185]
    v_pk_add_f32 v[182:183], v[182:183], v[186:187]
    v_pk_add_f32 v[180:181], v[180:181], v[182:183]
    v_add_f32 v15, v180, v181
    v_mul_f32 v15, 0x3b124925, v15
    v_fma_f32 v15, -v58, v58, v15
    v_max_f32 v15, 0, v15
    v_add_f32 v15, 0x3727c5ac, v15
    v_rsq_f32 v15, v15
    s_nop 0
    v_mov_b32 v224, v15
    v_pk_fma_f32 v[112:113], v[144:145], v[58:59], v[112:113] op_sel_hi:[1,0,1]
    v_pk_fma_f32 v[114:115], v[146:147], v[58:59], v[114:115] op_sel_hi:[1,0,1]
    v_pk_fma_f32 v[116:117], v[148:149], v[58:59], v[116:117] op_sel_hi:[1,0,1]
    v_pk_fma_f32 v[118:119], v[150:151], v[58:59], v[118:119] op_sel_hi:[1,0,1]
    v_pk_fma_f32 v[120:121], v[152:153], v[58:59], v[120:121] op_sel_hi:[1,0,1]
    v_pk_fma_f32 v[122:123], v[154:155], v[58:59], v[122:123] op_sel_hi:[1,0,1]
    v_pk_fma_f32 v[124:125], v[156:157], v[58:59], v[124:125] op_sel_hi:[1,0,1]
    v_pk_fma_f32 v[126:127], v[158:159], v[58:59], v[126:127] op_sel_hi:[1,0,1]
    s_add_u32 s72, s46, 1
    s_lshl_b32 s72, s72, 10
    v_subrev_u32 v16, s72, v34
    v_subrev_u32 v17, s72, v35
    v_pk_fma_f32 v[96:97], v[160:161], v[56:57], v[96:97] op_sel_hi:[1,0,1]
    v_pk_fma_f32 v[98:99], v[162:163], v[56:57], v[98:99] op_sel_hi:[1,0,1]
    v_pk_fma_f32 v[100:101], v[164:165], v[56:57], v[100:101] op_sel_hi:[1,0,1]
    v_pk_fma_f32 v[102:103], v[166:167], v[56:57], v[102:103] op_sel_hi:[1,0,1]
    v_pk_fma_f32 v[104:105], v[168:169], v[56:57], v[104:105] op_sel_hi:[1,0,1]
    v_pk_fma_f32 v[106:107], v[170:171], v[56:57], v[106:107] op_sel_hi:[1,0,1]
    v_pk_fma_f32 v[108:109], v[172:173], v[56:57], v[108:109] op_sel_hi:[1,0,1]
    v_pk_fma_f32 v[110:111], v[174:175], v[56:57], v[110:111] op_sel_hi:[1,0,1]
    v_pk_mul_f32 v[96:97], v[96:97], v[60:61] op_sel_hi:[1,0]
    v_pk_mul_f32 v[98:99], v[98:99], v[60:61] op_sel_hi:[1,0]
    v_pk_mul_f32 v[100:101], v[100:101], v[60:61] op_sel_hi:[1,0]
    v_pk_mul_f32 v[102:103], v[102:103], v[60:61] op_sel_hi:[1,0]
    v_pk_mul_f32 v[104:105], v[104:105], v[60:61] op_sel_hi:[1,0]
    v_pk_mul_f32 v[106:107], v[106:107], v[60:61] op_sel_hi:[1,0]
    v_pk_mul_f32 v[108:109], v[108:109], v[60:61] op_sel_hi:[1,0]
    v_pk_mul_f32 v[110:111], v[110:111], v[60:61] op_sel_hi:[1,0]
    v_cvt_pk_bf16_f32 v188, v96, v97
    v_cvt_pk_bf16_f32 v189, v98, v99
    v_cvt_pk_bf16_f32 v190, v100, v101
    v_cvt_pk_bf16_f32 v191, v102, v103
    v_cvt_pk_bf16_f32 v192, v104, v105
    v_cvt_pk_bf16_f32 v193, v106, v107
    v_cvt_pk_bf16_f32 v194, v108, v109
    v_cvt_pk_bf16_f32 v195, v110, v111
    ds_write_b128 v34, v[188:191] offset:20480
    ds_write_b128 v35, v[192:195] offset:20480
    s_cmp_lt_u32 s3, 4
    s_cbranch_scc1 P2_EP2A
    s_branch P2_EP2B
P2_EP2A:
    s_add_u32 m0, s91, 16384
    s_nop 0
    buffer_load_dwordx4 v252, s[92:95], s90 offen lds
    buffer_load_dwordx4 v253, s[92:95], s90 offen offset:1024 lds
    s_add_u32 s90, s90, 14336
    s_add_u32 m0, s91, 32768
    s_nop 0
    buffer_load_dwordx4 v252, s[92:95], s90 offen lds
    buffer_load_dwordx4 v254, s[92:95], s90 offen offset:1024 lds
    s_add_u32 s90, s90, s96
    s_add_u32 m0, s91, 114688
    s_nop 0
    buffer_load_dwordx4 v252, s[92:95], s90 offen lds
    buffer_load_dwordx4 v253, s[92:95], s90 offen offset:1024 lds
    s_add_u32 s90, s90, 14336
    s_add_u32 m0, s91, 131072
    s_nop 0
    buffer_load_dwordx4 v252, s[92:95], s90 offen lds
    buffer_load_dwordx4 v254, s[92:95], s90 offen offset:1024 lds
    s_add_u32 s90, s90, s96
    s_add_u32 m0, s91, 0
    s_nop 0
    buffer_load_dwordx4 v252, s[92:95], s90 offen lds
    buffer_load_dwordx4 v253, s[92:95], s90 offen offset:1024 lds
    s_add_u32 s90, s90, 14336
P2_EP2B:
    v_pk_mul_f32 v[112:113], v[112:113], v[224:225] op_sel_hi:[1,0]
    v_pk_mul_f32 v[114:115], v[114:115], v[224:225] op_sel_hi:[1,0]
    v_pk_mul_f32 v[116:117], v[116:117], v[224:225] op_sel_hi:[1,0]
    v_pk_mul_f32 v[118:119], v[118:119], v[224:225] op_sel_hi:[1,0]
    v_pk_mul_f32 v[120:121], v[120:121], v[224:225] op_sel_hi:[1,0]
    v_pk_mul_f32 v[122:123], v[122:123], v[224:225] op_sel_hi:[1,0]
    v_pk_mul_f32 v[124:125], v[124:125], v[224:225] op_sel_hi:[1,0]
    v_pk_mul_f32 v[126:127], v[126:127], v[224:225] op_sel_hi:[1,0]
    v_cvt_pk_bf16_f32 v196, v112, v113
    v_cvt_pk_bf16_f32 v197, v114, v115
    v_cvt_pk_bf16_f32 v198, v116, v117
    v_cvt_pk_bf16_f32 v199, v118, v119
    v_cvt_pk_bf16_f32 v200, v120, v121
    v_cvt_pk_bf16_f32 v201, v122, v123
    v_cvt_pk_bf16_f32 v202, v124, v125
    v_cvt_pk_bf16_f32 v203, v126, v127
    ds_write_b128 v16, v[196:199] offset:10240
    ds_write_b128 v17, v[200:203] offset:10240
    s_branch ATT_POST
ATT_V:
    s_waitcnt vmcnt(5) lgkmcnt(0)
    s_barrier
    ds_read_b128 v[128:131], v4 offset:0
    ds_read_b64_tr_b16 v[132:133], v6 offset:0
    ds_read_b64_tr_b16 v[134:135], v6 offset:512
    s_add_u32 m0, s53, 0
    s_nop 0
    buffer_load_dwordx4 v1, s[20:23], s52 offen lds
    ds_read_b64_tr_b16 v[136:137], v6 offset:8192
    ds_read_b64_tr_b16 v[138:139], v6 offset:8704
    ds_read_b64_tr_b16 v[140:141], v6 offset:16384
    ds_read_b64_tr_b16 v[142:143], v6 offset:16896
    s_add_u32 m0, s53, 1024
    s_add_u32 s49, s52, 896
    buffer_load_dwordx4 v1, s[20:23], s49 offen lds
    ds_read_b128 v[144:147], v8 offset:0
    ds_read_b128 v[148:151], v5 offset:0
    ds_read_b64_tr_b16 v[152:153], v7 offset:0
    ds_read_b64_tr_b16 v[154:155], v7 offset:512
    ds_read_b64_tr_b16 v[156:157], v7 offset:8192
    ds_read_b64_tr_b16 v[158:159], v7 offset:8704
    s_add_u32 m0, s57, 0
    s_mov_b64 exec, s[66:67]
    buffer_load_dwordx4 v2, s[24:27], s56 offen lds
    s_mov_b64 exec, -1
    ds_read_b64_tr_b16 v[160:161], v7 offset:16384
    ds_read_b64_tr_b16 v[162:163], v7 offset:16896
    ds_read_b128 v[164:167], v9 offset:0
    s_add_u32 m0, s57, 8192
    s_add_u32 s49, s56, 896
    s_mov_b64 exec, s[66:67]
    buffer_load_dwordx4 v2, s[24:27], s49 offen lds
    s_mov_b64 exec, -1
    s_cmp_eq_u32 s60, 2
    s_cselect_b32 s50, -2, 1
    s_mul_i32 s61, s50, 16384
    s_mul_i32 s62, s50, 3072
    s_mul_i32 s63, s50, 24576
    s_add_u32 s60, s60, 1
    s_cmp_eq_u32 s60, 3
    s_cselect_b32 s60, 0, s60
    ds_read_b128 v[168:171], v4 offset:512
    ds_read_b64_tr_b16 v[172:173], v6 offset:4096
    ds_read_b64_tr_b16 v[174:175], v6 offset:4608
    s_waitcnt lgkmcnt(11)
    v_mfma_f32_32x32x16_bf16 v[64:79], v[132:135], v[128:131], 0
    ds_read_b64_tr_b16 v[176:177], v6 offset:12288
    ds_read_b64_tr_b16 v[178:179], v6 offset:12800
    v_mfma_f32_32x32x16_bf16 v[80:95], v[136:139], v[128:131], 0
    ds_read_b64_tr_b16 v[180:181], v6 offset:20480
    ds_read_b64_tr_b16 v[182:183], v6 offset:20992
    v_mfma_f32_32x32x16_bf16 v[96:111], v[140:143], v[128:131], 0
    s_add_u32 m0, s57, 16384
    s_add_u32 s49, s56, 1792
    s_mov_b64 exec, s[66:67]
    buffer_load_dwordx4 v2, s[24:27], s49 offen lds
    s_mov_b64 exec, -1
    s_add_u32 s52, s52, 128
    s_add_u32 s54, s54, 128
    s_add_u32 s56, s56, 172032
    s_cmp_eq_u32 s59, 2
    s_cselect_b32 s50, -2, 1
    s_mul_i32 s49, s50, 16384
    s_add_u32 s53, s53, s49
    s_mul_i32 s49, s50, 3072
    s_add_u32 s55, s55, s49
    s_mul_i32 s49, s50, 24576
    s_add_u32 s57, s57, s49
    s_add_u32 s59, s59, 1
    s_cmp_eq_u32 s59, 3
    s_cselect_b32 s59, 0, s59
    ds_read_b128 v[184:187], v8 offset:512
    v_mfma_f32_32x32x16_bf16 v[112:127], v[140:143], v[144:147], 0
    ds_read_b128 v[188:191], v5 offset:512
    ds_read_b64_tr_b16 v[192:193], v7 offset:4096
    ds_read_b64_tr_b16 v[194:195], v7 offset:4608
    s_waitcnt lgkmcnt(11)
    v_mfma_f32_32x32x16_bf16 v[64:79], v[152:155], v[148:151], v[64:79]
    v_add_u32 v4, s61, v4
    v_add_u32 v6, s63, v6
    v_add_u32 v8, s62, v8
    v_and_b32 v14, s65, v148
    ds_read_b64_tr_b16 v[196:197], v7 offset:12288
    ds_read_b64_tr_b16 v[198:199], v7 offset:12800
    ds_read_b128 v[204:207], v9 offset:512
    v_mfma_f32_32x32x16_bf16 v[80:95], v[156:159], v[148:151], v[80:95]
    v_lshlrev_b32 v15, 16, v148
    v_fmac_f32 v10, v14, v14
    v_fmac_f32 v11, v15, v15
    v_and_b32 v14, s65, v149
    ds_read_b64_tr_b16 v[200:201], v7 offset:20480
    ds_read_b64_tr_b16 v[202:203], v7 offset:20992
    v_mfma_f32_32x32x16_bf16 v[96:111], v[160:163], v[148:151], v[96:111]
    v_lshlrev_b32 v15, 16, v149
    v_fmac_f32 v10, v14, v14
    v_fmac_f32 v11, v15, v15
    v_and_b32 v14, s65, v150
    v_mfma_f32_32x32x16_bf16 v[112:127], v[160:163], v[164:167], v[112:127]
    v_add_u32 v5, s61, v5
    v_add_u32 v7, s63, v7
    v_add_u32 v9, s62, v9
    v_lshlrev_b32 v15, 16, v150
    s_lshr_b32 s49, s2, 3
    s_mul_i32 s97, s49, 37
    s_lshr_b32 s97, s97, 8
    s_mul_i32 s50, s97, 7
    s_sub_u32 s98, s49, s50
    s_and_b32 s49, s2, 7
    s_lshl_b32 s49, s49, 2
    s_add_u32 s97, s97, s49
    s_mov_b32 s91, s3
    s_sub_u32 s49, s91, 2
    s_mul_i32 s99, s49, 19
    s_cmp_eq_u32 s91, 7
    s_cselect_b32 s99, 94, s99
    s_mul_i32 s49, s91, 200704
    s_mul_i32 s50, s99, 14336
    s_cmp_lt_u32 s91, 2
    s_cselect_b32 s90, s49, s50
    s_cselect_b32 s92, s8, s10
    s_cselect_b32 s93, s9, s11
    s_mov_b32 s94, 1605632
    s_cselect_b32 s94, 401408, s94
    s_mov_b32 s95, 0x20000
    s_mov_b32 s96, 14336
    s_cselect_b32 s96, 10752, s96
    s_mov_b32 s49, 6144
    s_cselect_b32 s49, 2560, s49
    s_cselect_b32 s50, 1073741824, 0
    s_cselect_b64 vcc, -1, 0
    v_lshrrev_b32 v240, 3, v0
    v_and_b32 v241, 7, v0
    v_bfe_u32 v242, v0, 4, 1
    v_lshlrev_b32 v242, 2, v242
    v_xor_b32 v242, v242, v241
    v_lshrrev_b32 v243, 2, v240
    v_and_b32 v244, 3, v240
    v_lshl_add_u32 v244, v243, 3, v244
    v_cndmask_b32 v240, v240, v244, vcc
    v_mul_u32_u24 v240, 896, v240
    v_lshl_add_u32 v252, v242, 4, v240
    v_add_u32 v253, s49, v252
    v_mul_lo_u32 v243, v243, s50
    v_add_u32 v254, v253, v243
    s_lshl_b32 s49, s98, 7
    s_add_u32 s90, s90, s49
    s_lshl_b32 s91, s91, 11
    s_mov_b32 s58, 4
    s_waitcnt vmcnt(5) lgkmcnt(0)
ATT_LA_V:
    s_barrier
    v_mfma_f32_32x32x16_bf16 v[64:79], v[172:175], v[168:171], v[64:79]
    s_add_u32 m0, s53, 0
    s_nop 0
    buffer_load_dwordx4 v1, s[20:23], s52 offen lds
    ds_read_b128 v[128:131], v4 offset:0
    ds_read_b64_tr_b16 v[132:133], v6 offset:0
    ds_read_b64_tr_b16 v[134:135], v6 offset:512
    v_fmac_f32 v10, v14, v14
    v_fmac_f32 v11, v15, v15
    ds_read_b64_tr_b16 v[136:137], v6 offset:8192
    ds_read_b64_tr_b16 v[138:139], v6 offset:8704
    v_mfma_f32_32x32x16_bf16 v[80:95], v[176:179], v[168:171], v[80:95]
    v_and_b32 v14, s65, v151
    v_lshlrev_b32 v15, 16, v151
    v_fmac_f32 v10, v14, v14
    v_fmac_f32 v11, v15, v15
    ds_read_b64_tr_b16 v[140:141], v6 offset:16384
    ds_read_b64_tr_b16 v[142:143], v6 offset:16896
    v_mfma_f32_32x32x16_bf16 v[96:111], v[180:183], v[168:171], v[96:111]
    s_add_u32 m0, s53, 1024
    s_add_u32 s49, s52, 896
    buffer_load_dwordx4 v1, s[20:23], s49 offen lds
    v_and_b32 v18, s65, v184
    v_lshlrev_b32 v19, 16, v184
    ds_read_b128 v[144:147], v8 offset:0
    v_mfma_f32_32x32x16_bf16 v[112:127], v[180:183], v[184:187], v[112:127]
    v_fmac_f32 v12, v18, v18
    v_fmac_f32 v13, v19, v19
    v_and_b32 v18, s65, v185
    v_lshlrev_b32 v19, 16, v185
    ds_read_b128 v[148:151], v5 offset:0
    ds_read_b64_tr_b16 v[152:153], v7 offset:0
    ds_read_b64_tr_b16 v[154:155], v7 offset:512
    v_mfma_f32_32x32x16_bf16 v[64:79], v[192:195], v[188:191], v[64:79]
    v_fmac_f32 v12, v18, v18
    v_fmac_f32 v13, v19, v19
    v_and_b32 v18, s65, v186
    v_lshlrev_b32 v19, 16, v186
    ds_read_b64_tr_b16 v[156:157], v7 offset:8192
    ds_read_b64_tr_b16 v[158:159], v7 offset:8704
    v_mfma_f32_32x32x16_bf16 v[80:95], v[196:199], v[188:191], v[80:95]
    s_add_u32 m0, s57, 0
    s_mov_b64 exec, s[66:67]
    buffer_load_dwordx4 v2, s[24:27], s56 offen lds
    s_mov_b64 exec, -1
    v_fmac_f32 v12, v18, v18
    v_fmac_f32 v13, v19, v19
    ds_read_b64_tr_b16 v[160:161], v7 offset:16384
    ds_read_b64_tr_b16 v[162:163], v7 offset:16896
    v_mfma_f32_32x32x16_bf16 v[96:111], v[200:203], v[188:191], v[96:111]
    v_and_b32 v18, s65, v187
    v_lshlrev_b32 v19, 16, v187
    v_fmac_f32 v12, v18, v18
    v_fmac_f32 v13, v19, v19
    ds_read_b128 v[164:167], v9 offset:0
    v_mfma_f32_32x32x16_bf16 v[112:127], v[200:203], v[204:207], v[112:127]
    s_add_u32 m0, s57, 8192
    s_add_u32 s49, s56, 896
    s_mov_b64 exec, s[66:67]
    buffer_load_dwordx4 v2, s[24:27], s49 offen lds
    s_mov_b64 exec, -1
    v_and_b32 v16, s65, v188
    v_lshlrev_b32 v17, 16, v188
    s_cmp_eq_u32 s60, 2
    s_cselect_b32 s50, -2, 1
    s_mul_i32 s61, s50, 16384
    s_mul_i32 s62, s50, 3072
    s_mul_i32 s63, s50, 24576
    s_add_u32 s60, s60, 1
    s_cmp_eq_u32 s60, 3
    s_cselect_b32 s60, 0, s60
    ds_read_b128 v[168:171], v4 offset:512
    ds_read_b64_tr_b16 v[172:173], v6 offset:4096
    ds_read_b64_tr_b16 v[174:175], v6 offset:4608
    s_waitcnt lgkmcnt(11)
    v_mfma_f32_32x32x16_bf16 v[64:79], v[132:135], v[128:131], v[64:79]
    v_fmac_f32 v10, v16, v16
    v_fmac_f32 v11, v17, v17
    v_and_b32 v16, s65, v189
    v_lshlrev_b32 v17, 16, v189
    ds_read_b64_tr_b16 v[176:177], v6 offset:12288
    ds_read_b64_tr_b16 v[178:179], v6 offset:12800
    v_mfma_f32_32x32x16_bf16 v[80:95], v[136:139], v[128:131], v[80:95]
    v_fmac_f32 v10, v16, v16
    v_fmac_f32 v11, v17, v17
    v_and_b32 v16, s65, v190
    v_lshlrev_b32 v17, 16, v190
    ds_read_b64_tr_b16 v[180:181], v6 offset:20480
    ds_read_b64_tr_b16 v[182:183], v6 offset:20992
    v_mfma_f32_32x32x16_bf16 v[96:111], v[140:143], v[128:131], v[96:111]
    s_add_u32 m0, s57, 16384
    s_add_u32 s49, s56, 1792
    s_mov_b64 exec, s[66:67]
    buffer_load_dwordx4 v2, s[24:27], s49 offen lds
    s_mov_b64 exec, -1
    s_add_u32 s52, s52, 128
    s_add_u32 s54, s54, 128
    s_add_u32 s56, s56, 172032
    s_cmp_eq_u32 s59, 2
    s_cselect_b32 s50, -2, 1
    s_mul_i32 s49, s50, 16384
    s_add_u32 s53, s53, s49
    s_mul_i32 s49, s50, 3072
    s_add_u32 s55, s55, s49
    s_mul_i32 s49, s50, 24576
    s_add_u32 s57, s57, s49
    s_add_u32 s59, s59, 1
    s_cmp_eq_u32 s59, 3
    s_cselect_b32 s59, 0, s59
    v_fmac_f32 v10, v16, v16
    v_fmac_f32 v11, v17, v17
    ds_read_b128 v[184:187], v8 offset:512
    v_mfma_f32_32x32x16_bf16 v[112:127], v[140:143], v[144:147], v[112:127]
    v_and_b32 v16, s65, v191
    v_lshlrev_b32 v17, 16, v191
    v_fmac_f32 v10, v16, v16
    v_fmac_f32 v11, v17, v17
    ds_read_b128 v[188:191], v5 offset:512
    ds_read_b64_tr_b16 v[192:193], v7 offset:4096
    ds_read_b64_tr_b16 v[194:195], v7 offset:4608
    s_waitcnt lgkmcnt(11)
    v_mfma_f32_32x32x16_bf16 v[64:79], v[152:155], v[148:151], v[64:79]
    v_add_u32 v4, s61, v4
    v_add_u32 v6, s63, v6
    v_add_u32 v8, s62, v8
    v_and_b32 v14, s65, v148
    ds_read_b64_tr_b16 v[196:197], v7 offset:12288
    ds_read_b64_tr_b16 v[198:199], v7 offset:12800
    ds_read_b128 v[204:207], v9 offset:512
    v_mfma_f32_32x32x16_bf16 v[80:95], v[156:159], v[148:151], v[80:95]
    v_lshlrev_b32 v15, 16, v148
    v_fmac_f32 v10, v14, v14
    v_fmac_f32 v11, v15, v15
    v_and_b32 v14, s65, v149
    ds_read_b64_tr_b16 v[200:201], v7 offset:20480
    ds_read_b64_tr_b16 v[202:203], v7 offset:20992
    v_mfma_f32_32x32x16_bf16 v[96:111], v[160:163], v[148:151], v[96:111]
    v_lshlrev_b32 v15, 16, v149
    v_fmac_f32 v10, v14, v14
    v_fmac_f32 v11, v15, v15
    v_and_b32 v14, s65, v150
    v_mfma_f32_32x32x16_bf16 v[112:127], v[160:163], v[164:167], v[112:127]
    v_add_u32 v5, s61, v5
    v_add_u32 v7, s63, v7
    v_add_u32 v9, s62, v9
    v_lshlrev_b32 v15, 16, v150
    s_sub_u32 s58, s58, 1
    s_cmp_lg_u32 s58, 0
    s_waitcnt vmcnt(5) lgkmcnt(0)
    s_cbranch_scc1 ATT_LA_V
    v_lshlrev_b32 v250, 7, v0
    buffer_load_dword v251, v250, s[32:35], s77 offen
    s_mov_b32 s58, 2
ATT_LB_V:
    s_barrier
    v_mfma_f32_32x32x16_bf16 v[64:79], v[172:175], v[168:171], v[64:79]
    ds_read_b128 v[128:131], v4 offset:0
    ds_read_b64_tr_b16 v[132:133], v6 offset:0
    ds_read_b64_tr_b16 v[134:135], v6 offset:512
    v_fmac_f32 v10, v14, v14
    v_fmac_f32 v11, v15, v15
    ds_read_b64_tr_b16 v[136:137], v6 offset:8192
    ds_read_b64_tr_b16 v[138:139], v6 offset:8704
    v_mfma_f32_32x32x16_bf16 v[80:95], v[176:179], v[168:171], v[80:95]
    v_and_b32 v14, s65, v151
    v_lshlrev_b32 v15, 16, v151
    v_fmac_f32 v10, v14, v14
    v_fmac_f32 v11, v15, v15
    ds_read_b64_tr_b16 v[140:141], v6 offset:16384
    ds_read_b64_tr_b16 v[142:143], v6 offset:16896
    v_mfma_f32_32x32x16_bf16 v[96:111], v[180:183], v[168:171], v[96:111]
    v_and_b32 v18, s65, v184
    v_lshlrev_b32 v19, 16, v184
    ds_read_b128 v[144:147], v8 offset:0
    v_mfma_f32_32x32x16_bf16 v[112:127], v[180:183], v[184:187], v[112:127]
    v_fmac_f32 v12, v18, v18
    v_fmac_f32 v13, v19, v19
    v_and_b32 v18, s65, v185
    v_lshlrev_b32 v19, 16, v185
    ds_read_b128 v[148:151], v5 offset:0
    ds_read_b64_tr_b16 v[152:153], v7 offset:0
    ds_read_b64_tr_b16 v[154:155], v7 offset:512
    v_mfma_f32_32x32x16_bf16 v[64:79], v[192:195], v[188:191], v[64:79]
    v_fmac_f32 v12, v18, v18
    v_fmac_f32 v13, v19, v19
    v_and_b32 v18, s65, v186
    v_lshlrev_b32 v19, 16, v186
    ds_read_b64_tr_b16 v[156:157], v7 offset:8192
    ds_read_b64_tr_b16 v[158:159], v7 offset:8704
    v_mfma_f32_32x32x16_bf16 v[80:95], v[196:199], v[188:191], v[80:95]
    v_fmac_f32 v12, v18, v18
    v_fmac_f32 v13, v19, v19
    ds_read_b64_tr_b16 v[160:161], v7 offset:16384
    ds_read_b64_tr_b16 v[162:163], v7 offset:16896
    v_mfma_f32_32x32x16_bf16 v[96:111], v[200:203], v[188:191], v[96:111]
    v_and_b32 v18, s65, v187
    v_lshlrev_b32 v19, 16, v187
    v_fmac_f32 v12, v18, v18
    v_fmac_f32 v13, v19, v19
    ds_read_b128 v[164:167], v9 offset:0
    v_mfma_f32_32x32x16_bf16 v[112:127], v[200:203], v[204:207], v[112:127]
    v_and_b32 v16, s65, v188
    v_lshlrev_b32 v17, 16, v188
    s_cmp_eq_u32 s60, 2
    s_cselect_b32 s50, -2, 1
    s_mul_i32 s61, s50, 16384
    s_mul_i32 s62, s50, 3072
    s_mul_i32 s63, s50, 24576
    s_add_u32 s60, s60, 1
    s_cmp_eq_u32 s60, 3
    s_cselect_b32 s60, 0, s60
    ds_read_b128 v[168:171], v4 offset:512
    ds_read_b64_tr_b16 v[172:173], v6 offset:4096
    ds_read_b64_tr_b16 v[174:175], v6 offset:4608
    s_waitcnt lgkmcnt(11)
    v_mfma_f32_32x32x16_bf16 v[64:79], v[132:135], v[128:131], v[64:79]
    v_fmac_f32 v10, v16, v16
    v_fmac_f32 v11, v17, v17
    v_and_b32 v16, s65, v189
    v_lshlrev_b32 v17, 16, v189
    ds_read_b64_tr_b16 v[176:177], v6 offset:12288
    ds_read_b64_tr_b16 v[178:179], v6 offset:12800
    v_mfma_f32_32x32x16_bf16 v[80:95], v[136:139], v[128:131], v[80:95]
    v_fmac_f32 v10, v16, v16
    v_fmac_f32 v11, v17, v17
    v_and_b32 v16, s65, v190
    v_lshlrev_b32 v17, 16, v190
    ds_read_b64_tr_b16 v[180:181], v6 offset:20480
    ds_read_b64_tr_b16 v[182:183], v6 offset:20992
    v_mfma_f32_32x32x16_bf16 v[96:111], v[140:143], v[128:131], v[96:111]
    v_fmac_f32 v10, v16, v16
    v_fmac_f32 v11, v17, v17
    ds_read_b128 v[184:187], v8 offset:512
    v_mfma_f32_32x32x16_bf16 v[112:127], v[140:143], v[144:147], v[112:127]
    v_and_b32 v16, s65, v191
    v_lshlrev_b32 v17, 16, v191
    v_fmac_f32 v10, v16, v16
    v_fmac_f32 v11, v17, v17
    ds_read_b128 v[188:191], v5 offset:512
    ds_read_b64_tr_b16 v[192:193], v7 offset:4096
    ds_read_b64_tr_b16 v[194:195], v7 offset:4608
    s_waitcnt lgkmcnt(11)
    v_mfma_f32_32x32x16_bf16 v[64:79], v[152:155], v[148:151], v[64:79]
    v_add_u32 v4, s61, v4
    v_add_u32 v6, s63, v6
    v_add_u32 v8, s62, v8
    v_and_b32 v14, s65, v148
    ds_read_b64_tr_b16 v[196:197], v7 offset:12288
    ds_read_b64_tr_b16 v[198:199], v7 offset:12800
    ds_read_b128 v[204:207], v9 offset:512
    v_mfma_f32_32x32x16_bf16 v[80:95], v[156:159], v[148:151], v[80:95]
    v_lshlrev_b32 v15, 16, v148
    v_fmac_f32 v10, v14, v14
    v_fmac_f32 v11, v15, v15
    v_and_b32 v14, s65, v149
    ds_read_b64_tr_b16 v[200:201], v7 offset:20480
    ds_read_b64_tr_b16 v[202:203], v7 offset:20992
    v_mfma_f32_32x32x16_bf16 v[96:111], v[160:163], v[148:151], v[96:111]
    v_lshlrev_b32 v15, 16, v149
    v_fmac_f32 v10, v14, v14
    v_fmac_f32 v11, v15, v15
    v_and_b32 v14, s65, v150
    v_mfma_f32_32x32x16_bf16 v[112:127], v[160:163], v[164:167], v[112:127]
    v_add_u32 v5, s61, v5
    v_add_u32 v7, s63, v7
    v_add_u32 v9, s62, v9
    v_lshlrev_b32 v15, 16, v150
    s_sub_u32 s58, s58, 1
    s_cmp_eq_u32 s58, 0
    s_cbranch_scc1 ATT_LX_V
    s_waitcnt vmcnt(1) lgkmcnt(0)
    v_lshlrev_b32 v250, 7, v0
    buffer_load_dword v251, v250, s[32:35], s79 offen
    s_branch ATT_LB_V
ATT_LX_V:
    s_waitcnt lgkmcnt(0)
    v_mfma_f32_32x32x16_bf16 v[112:127], v[180:183], v[184:187], v[112:127]
    v_fmac_f32 v10, v14, v14
    v_fmac_f32 v11, v15, v15
    v_and_b32 v14, s65, v151
    v_lshlrev_b32 v15, 16, v151
    v_fmac_f32 v10, v14, v14
    v_fmac_f32 v11, v15, v15
    v_and_b32 v18, s65, v184
    v_lshlrev_b32 v19, 16, v184
    v_mfma_f32_32x32x16_bf16 v[112:127], v[200:203], v[204:207], v[112:127]
    v_fmac_f32 v12, v18, v18
    v_fmac_f32 v13, v19, v19
    v_and_b32 v18, s65, v185
    v_lshlrev_b32 v19, 16, v185
    v_fmac_f32 v12, v18, v18
    v_fmac_f32 v13, v19, v19
    v_and_b32 v18, s65, v186
    v_lshlrev_b32 v19, 16, v186
    v_mfma_f32_32x32x16_bf16 v[64:79], v[172:175], v[168:171], v[64:79]
    v_fmac_f32 v12, v18, v18
    v_fmac_f32 v13, v19, v19
    v_and_b32 v18, s65, v187
    v_lshlrev_b32 v19, 16, v187
    v_fmac_f32 v12, v18, v18
    v_fmac_f32 v13, v19, v19
    v_and_b32 v16, s65, v188
    v_lshlrev_b32 v17, 16, v188
    v_mfma_f32_32x32x16_bf16 v[64:79], v[192:195], v[188:191], v[64:79]
    v_fmac_f32 v10, v16, v16
    v_fmac_f32 v11, v17, v17
    v_and_b32 v16, s65, v189
    v_lshlrev_b32 v17, 16, v189
    v_fmac_f32 v10, v16, v16
    v_fmac_f32 v11, v17, v17
    v_and_b32 v16, s65, v190
    v_lshlrev_b32 v17, 16, v190
    v_mfma_f32_32x32x16_bf16 v[80:95], v[176:179], v[168:171], v[80:95]
    v_fmac_f32 v10, v16, v16
    v_fmac_f32 v11, v17, v17
    v_and_b32 v16, s65, v191
    v_lshlrev_b32 v17, 16, v191
    v_fmac_f32 v10, v16, v16
    v_fmac_f32 v11, v17, v17
    v_mfma_f32_32x32x16_bf16 v[80:95], v[196:199], v[188:191], v[80:95]
    v_add_f32 v10, v10, v11
    ds_write_b32 v28, v10
    v_add_f32 v12, v12, v13
    ds_write_b32 v30, v12
    s_mov_b32 exec_lo, 1
    s_mov_b32 exec_hi, 1
    ds_write_b128 v33, v[112:115] offset:256
    ds_write_b128 v33, v[116:119] offset:272
    ds_write_b128 v33, v[120:123] offset:288
    ds_write_b128 v33, v[124:127] offset:304
    s_mov_b64 exec, -1
    v_mov_b32 v58, v124
    s_nop 1
    v_permlane32_swap_b32 v124, v58
    v_mul_f32 v58, 0xbb124925, v58
    v_mov_b32 v56, v76
    s_nop 1
    v_permlane32_swap_b32 v76, v56
    v_mul_f32 v56, 0xbb124925, v56
    s_waitcnt lgkmcnt(0)
    s_barrier
    ds_read_b128 v[176:179], v29
    ds_read_b128 v[128:131], v33 offset:0
    ds_read_b128 v[132:135], v33 offset:16
    ds_read_b128 v[136:139], v33 offset:32
    ds_read_b128 v[140:143], v33 offset:48
    v_mfma_f32_32x32x16_bf16 v[96:111], v[180:183], v[168:171], v[96:111]
    v_mfma_f32_32x32x16_bf16 v[96:111], v[200:203], v[188:191], v[96:111]
    ds_read_b128 v[144:147], v33 offset:128
    ds_read_b128 v[148:151], v33 offset:144
    ds_read_b128 v[152:155], v33 offset:160
    ds_read_b128 v[156:159], v33 offset:176
    ds_read_b128 v[160:163], v33 offset:256
    ds_read_b128 v[164:167], v33 offset:272
    ds_read_b128 v[168:171], v33 offset:288
    ds_read_b128 v[172:175], v33 offset:304
    ds_read_b128 v[180:183], v31
    ds_read_b128 v[184:187], v31 offset:16
    s_waitcnt lgkmcnt(10)
    v_pk_add_f32 v[176:177], v[176:177], v[178:179]
    v_add_f32 v14, v176, v177
    v_mul_f32 v14, 0x3b124925, v14
    v_fma_f32 v14, -v56, v56, v14
    v_max_f32 v14, 0, v14
    v_add_f32 v14, 0x3727c5ac, v14
    v_rsq_f32 v14, v14
    s_nop 0
    v_mov_b32 v60, v14
    v_mul_f32 v62, 0x3e8b97f6, v14
    v_pk_fma_f32 v[64:65], v[128:129], v[56:57], v[64:65] op_sel_hi:[1,0,1]
    v_pk_fma_f32 v[66:67], v[130:131], v[56:57], v[66:67] op_sel_hi:[1,0,1]
    v_pk_fma_f32 v[68:69], v[132:133], v[56:57], v[68:69] op_sel_hi:[1,0,1]
    v_pk_fma_f32 v[70:71], v[134:135], v[56:57], v[70:71] op_sel_hi:[1,0,1]
    v_pk_fma_f32 v[72:73], v[136:137], v[56:57], v[72:73] op_sel_hi:[1,0,1]
    v_pk_fma_f32 v[74:75], v[138:139], v[56:57], v[74:75] op_sel_hi:[1,0,1]
    v_pk_fma_f32 v[76:77], v[140:141], v[56:57], v[76:77] op_sel_hi:[1,0,1]
    v_pk_fma_f32 v[78:79], v[142:143], v[56:57], v[78:79] op_sel_hi:[1,0,1]
    v_pk_mul_f32 v[64:65], v[64:65], v[62:63] op_sel_hi:[1,0]
    v_pk_mul_f32 v[66:67], v[66:67], v[62:63] op_sel_hi:[1,0]
    v_pk_mul_f32 v[68:69], v[68:69], v[62:63] op_sel_hi:[1,0]
    v_pk_mul_f32 v[70:71], v[70:71], v[62:63] op_sel_hi:[1,0]
    v_pk_mul_f32 v[72:73], v[72:73], v[62:63] op_sel_hi:[1,0]
    v_pk_mul_f32 v[74:75], v[74:75], v[62:63] op_sel_hi:[1,0]
    v_pk_mul_f32 v[76:77], v[76:77], v[62:63] op_sel_hi:[1,0]
    v_pk_mul_f32 v[78:79], v[78:79], v[62:63] op_sel_hi:[1,0]
    v_cvt_pk_bf16_f32 v188, v64, v65
    v_cvt_pk_bf16_f32 v189, v66, v67
    v_cvt_pk_bf16_f32 v190, v68, v69
    v_cvt_pk_bf16_f32 v191, v70, v71
    v_cvt_pk_bf16_f32 v192, v72, v73
    v_cvt_pk_bf16_f32 v193, v74, v75
    v_cvt_pk_bf16_f32 v194, v76, v77
    v_cvt_pk_bf16_f32 v195, v78, v79
    v_cndmask_b32 v194, 0, v194, s[68:69]
    v_cndmask_b32 v195, 0, v195, s[68:69]
    ds_write_b128 v34, v[188:191] offset:0
    ds_write_b128 v35, v[192:195] offset:0
    s_waitcnt lgkmcnt(8)
    v_pk_fma_f32 v[80:81], v[144:145], v[56:57], v[80:81] op_sel_hi:[1,0,1]
    v_pk_fma_f32 v[82:83], v[146:147], v[56:57], v[82:83] op_sel_hi:[1,0,1]
    v_pk_fma_f32 v[84:85], v[148:149], v[56:57], v[84:85] op_sel_hi:[1,0,1]
    v_pk_fma_f32 v[86:87], v[150:151], v[56:57], v[86:87] op_sel_hi:[1,0,1]
    v_pk_fma_f32 v[88:89], v[152:153], v[56:57], v[88:89] op_sel_hi:[1,0,1]
    v_pk_fma_f32 v[90:91], v[154:155], v[56:57], v[90:91] op_sel_hi:[1,0,1]
    v_pk_fma_f32 v[92:93], v[156:157], v[56:57], v[92:93] op_sel_hi:[1,0,1]
    v_pk_fma_f32 v[94:95], v[158:159], v[56:57], v[94:95] op_sel_hi:[1,0,1]
    v_pk_mul_f32 v[80:81], v[80:81], v[60:61] op_sel_hi:[1,0]
    v_pk_mul_f32 v[82:83], v[82:83], v[60:61] op_sel_hi:[1,0]
    v_pk_mul_f32 v[84:85], v[84:85], v[60:61] op_sel_hi:[1,0]
    v_pk_mul_f32 v[86:87], v[86:87], v[60:61] op_sel_hi:[1,0]
    v_pk_mul_f32 v[88:89], v[88:89], v[60:61] op_sel_hi:[1,0]
    v_pk_mul_f32 v[90:91], v[90:91], v[60:61] op_sel_hi:[1,0]
    v_pk_mul_f32 v[92:93], v[92:93], v[60:61] op_sel_hi:[1,0]
    v_pk_mul_f32 v[94:95], v[94:95], v[60:61] op_sel_hi:[1,0]
    v_cvt_pk_bf16_f32 v196, v80, v81
    v_cvt_pk_bf16_f32 v197, v82, v83
    v_cvt_pk_bf16_f32 v198, v84, v85
    v_cvt_pk_bf16_f32 v199, v86, v87
    v_cvt_pk_bf16_f32 v200, v88, v89
    v_cvt_pk_bf16_f32 v201, v90, v91
    v_cvt_pk_bf16_f32 v202, v92, v93
    v_cvt_pk_bf16_f32 v203, v94, v95
    ds_write_b128 v34, v[196:199] offset:10240
    ds_write_b128 v35, v[200:203] offset:10240
    s_waitcnt lgkmcnt(6)
    s_waitcnt lgkmcnt(4)
    v_pk_add_f32 v[180:181], v[180:181], v[184:185]
    v_pk_add_f32 v[182:183], v[182:183], v[186:187]
    v_pk_add_f32 v[180:181], v[180:181], v[182:183]
    v_add_f32 v15, v180, v181
    v_mul_f32 v15, 0x3b124925, v15
    v_fma_f32 v15, -v58, v58, v15
    v_max_f32 v15, 0, v15
    v_add_f32 v15, 0x3727c5ac, v15
    v_rsq_f32 v15, v15
    s_nop 0
    v_mov_b32 v224, v15
    v_pk_fma_f32 v[112:113], v[160:161], v[58:59], v[112:113] op_sel_hi:[1,0,1]
    v_pk_fma_f32 v[114:115], v[162:163], v[58:59], v[114:115] op_sel_hi:[1,0,1]
    v_pk_fma_f32 v[116:117], v[164:165], v[58:59], v[116:117] op_sel_hi:[1,0,1]
    v_pk_fma_f32 v[118:119], v[166:167], v[58:59], v[118:119] op_sel_hi:[1,0,1]
    v_pk_fma_f32 v[120:121], v[168:169], v[58:59], v[120:121] op_sel_hi:[1,0,1]
    v_pk_fma_f32 v[122:123], v[170:171], v[58:59], v[122:123] op_sel_hi:[1,0,1]
    v_pk_fma_f32 v[124:125], v[172:173], v[58:59], v[124:125] op_sel_hi:[1,0,1]
    v_pk_fma_f32 v[126:127], v[174:175], v[58:59], v[126:127] op_sel_hi:[1,0,1]
    s_add_u32 s72, s46, 1
    s_lshl_b32 s72, s72, 10
    v_subrev_u32 v16, s72, v34
    v_subrev_u32 v17, s72, v35
    v_pk_fma_f32 v[96:97], v[160:161], v[56:57], v[96:97] op_sel_hi:[1,0,1]
    v_pk_fma_f32 v[98:99], v[162:163], v[56:57], v[98:99] op_sel_hi:[1,0,1]
    v_pk_fma_f32 v[100:101], v[164:165], v[56:57], v[100:101] op_sel_hi:[1,0,1]
    v_pk_fma_f32 v[102:103], v[166:167], v[56:57], v[102:103] op_sel_hi:[1,0,1]
    v_pk_fma_f32 v[104:105], v[168:169], v[56:57], v[104:105] op_sel_hi:[1,0,1]
    v_pk_fma_f32 v[106:107], v[170:171], v[56:57], v[106:107] op_sel_hi:[1,0,1]
    v_pk_fma_f32 v[108:109], v[172:173], v[56:57], v[108:109] op_sel_hi:[1,0,1]
    v_pk_fma_f32 v[110:111], v[174:175], v[56:57], v[110:111] op_sel_hi:[1,0,1]
    v_pk_mul_f32 v[96:97], v[96:97], v[60:61] op_sel_hi:[1,0]
    v_pk_mul_f32 v[98:99], v[98:99], v[60:61] op_sel_hi:[1,0]
    v_pk_mul_f32 v[100:101], v[100:101], v[60:61] op_sel_hi:[1,0]
    v_pk_mul_f32 v[102:103], v[102:103], v[60:61] op_sel_hi:[1,0]
    v_pk_mul_f32 v[104:105], v[104:105], v[60:61] op_sel_hi:[1,0]
    v_pk_mul_f32 v[106:107], v[106:107], v[60:61] op_sel_hi:[1,0]
    v_pk_mul_f32 v[108:109], v[108:109], v[60:61] op_sel_hi:[1,0]
    v_pk_mul_f32 v[110:111], v[110:111], v[60:61] op_sel_hi:[1,0]
    v_cvt_pk_bf16_f32 v188, v96, v97
    v_cvt_pk_bf16_f32 v189, v98, v99
    v_cvt_pk_bf16_f32 v190, v100, v101
    v_cvt_pk_bf16_f32 v191, v102, v103
    v_cvt_pk_bf16_f32 v192, v104, v105
    v_cvt_pk_bf16_f32 v193, v106, v107
    v_cvt_pk_bf16_f32 v194, v108, v109
    v_cvt_pk_bf16_f32 v195, v110, v111
    ds_write_b128 v34, v[188:191] offset:20480
    ds_write_b128 v35, v[192:195] offset:20480
    s_cmp_lt_u32 s3, 4
    s_cbranch_scc1 P2_EP3A
    s_branch P2_EP3B
P2_EP3A:
    s_add_u32 m0, s91, 16384
    s_nop 0
    buffer_load_dwordx4 v252, s[92:95], s90 offen lds
    buffer_load_dwordx4 v253, s[92:95], s90 offen offset:1024 lds
    s_add_u32 s90, s90, 14336
    s_add_u32 m0, s91, 32768
    s_nop 0
    buffer_load_dwordx4 v252, s[92:95], s90 offen lds
    buffer_load_dwordx4 v254, s[92:95], s90 offen offset:1024 lds
    s_add_u32 s90, s90, s96
    s_add_u32 m0, s91, 114688
    s_nop 0
    buffer_load_dwordx4 v252, s[92:95], s90 offen lds
    buffer_load_dwordx4 v253, s[92:95], s90 offen offset:1024 lds
    s_add_u32 s90, s90, 14336
    s_add_u32 m0, s91, 131072
    s_nop 0
    buffer_load_dwordx4 v252, s[92:95], s90 offen lds
    buffer_load_dwordx4 v254, s[92:95], s90 offen offset:1024 lds
    s_add_u32 s90, s90, s96
    s_add_u32 m0, s91, 0
    s_nop 0
    buffer_load_dwordx4 v252, s[92:95], s90 offen lds
    buffer_load_dwordx4 v253, s[92:95], s90 offen offset:1024 lds
    s_add_u32 s90, s90, 14336
P2_EP3B:
    v_pk_mul_f32 v[112:113], v[112:113], v[224:225] op_sel_hi:[1,0]
    v_pk_mul_f32 v[114:115], v[114:115], v[224:225] op_sel_hi:[1,0]
    v_pk_mul_f32 v[116:117], v[116:117], v[224:225] op_sel_hi:[1,0]
    v_pk_mul_f32 v[118:119], v[118:119], v[224:225] op_sel_hi:[1,0]
    v_pk_mul_f32 v[120:121], v[120:121], v[224:225] op_sel_hi:[1,0]
    v_pk_mul_f32 v[122:123], v[122:123], v[224:225] op_sel_hi:[1,0]
    v_pk_mul_f32 v[124:125], v[124:125], v[224:225] op_sel_hi:[1,0]
    v_pk_mul_f32 v[126:127], v[126:127], v[224:225] op_sel_hi:[1,0]
    v_cvt_pk_bf16_f32 v196, v112, v113
    v_cvt_pk_bf16_f32 v197, v114, v115
    v_cvt_pk_bf16_f32 v198, v116, v117
    v_cvt_pk_bf16_f32 v199, v118, v119
    v_cvt_pk_bf16_f32 v200, v120, v121
    v_cvt_pk_bf16_f32 v201, v122, v123
    v_cvt_pk_bf16_f32 v202, v124, v125
    v_cvt_pk_bf16_f32 v203, v126, v127
    ds_write_b128 v16, v[196:199] offset:20480
    ds_write_b128 v17, v[200:203] offset:20480
ATT_POST:
    s_waitcnt lgkmcnt(0)
    s_barrier
    ds_read_b128 v[128:131], v36 offset:1024
    ds_read_b128 v[132:135], v36 offset:10240
    ds_read_b128 v[136:139], v36 offset:11264
    ds_read_b128 v[168:171], v36 offset:6144
    ds_read_b128 v[172:175], v36 offset:15360
    ds_read_b128 v[176:179], v36 offset:16384
    ds_read_b64_tr_b16 v[140:141], v37 offset:20480
    ds_read_b64_tr_b16 v[142:143], v37 offset:21504
    ds_read_b64_tr_b16 v[144:145], v38 offset:20480
    ds_read_b64_tr_b16 v[146:147], v38 offset:21504
    ds_read_b64_tr_b16 v[180:181], v37 offset:25600
    ds_read_b64_tr_b16 v[182:183], v37 offset:26624
    ds_read_b64_tr_b16 v[184:185], v38 offset:25600
    ds_read_b64_tr_b16 v[186:187], v38 offset:26624
    s_cmp_lt_u32 s3, 4
    s_cbranch_scc1 P2_EP4A
    s_add_u32 m0, s91, 16384
    s_nop 0
    buffer_load_dwordx4 v252, s[92:95], s90 offen lds
    buffer_load_dwordx4 v253, s[92:95], s90 offen offset:1024 lds
    s_add_u32 s90, s90, 14336
    s_add_u32 m0, s91, 32768
    s_nop 0
    buffer_load_dwordx4 v252, s[92:95], s90 offen lds
    buffer_load_dwordx4 v254, s[92:95], s90 offen offset:1024 lds
    s_add_u32 s90, s90, s96
    s_add_u32 m0, s91, 114688
    s_nop 0
    buffer_load_dwordx4 v252, s[92:95], s90 offen lds
    buffer_load_dwordx4 v253, s[92:95], s90 offen offset:1024 lds
    s_add_u32 s90, s90, 14336
P2_EP4A:
    s_waitcnt lgkmcnt(11)
    v_mfma_f32_16x16x32_bf16 v[148:151], v[132:135], v[128:131], v[44:47]
    v_mfma_f32_16x16x32_bf16 v[152:155], v[136:139], v[128:131], v[40:43]
    s_waitcnt lgkmcnt(8)
    v_mfma_f32_16x16x32_bf16 v[188:191], v[172:175], v[168:171], v[44:47]
    v_mfma_f32_16x16x32_bf16 v[192:195], v[176:179], v[168:171], v[40:43]
    s_cmp_lt_u32 s3, 4
    s_cbranch_scc1 P2_EP5A
    s_add_u32 m0, s91, 131072
    s_nop 0
    buffer_load_dwordx4 v252, s[92:95], s90 offen lds
    buffer_load_dwordx4 v254, s[92:95], s90 offen offset:1024 lds
    s_add_u32 s90, s90, s96
    s_add_u32 m0, s91, 0
    s_nop 0
    buffer_load_dwordx4 v252, s[92:95], s90 offen lds
    buffer_load_dwordx4 v253, s[92:95], s90 offen offset:1024 lds
    s_add_u32 s90, s90, 14336
P2_EP5A:
    s_nop 2
    v_max_f32 v152, v152, v148
    s_nop 1
    v_max_f32 v192, v192, v188
    v_max_f32 v153, v153, v149
    v_max_f32 v193, v193, v189
    v_max_f32 v154, v154, v150
    v_max_f32 v194, v194, v190
    v_max_f32 v155, v155, v151
    v_max_f32 v195, v195, v191
    v_max3_f32 v156, v152, v153, v154
    v_max3_f32 v196, v192, v193, v194
    v_max_f32 v156, v156, v155
    v_max_f32 v196, v196, v195
    v_mov_b32 v157, v156
    v_mov_b32 v197, v196
    s_nop 0
    v_permlane32_swap_b32 v156, v157
    v_permlane32_swap_b32 v196, v197
    v_max_f32 v156, v156, v157
    v_max_f32 v196, v196, v197
    v_mov_b32 v157, v156
    v_mov_b32 v197, v196
    s_nop 0
    v_permlane16_swap_b32 v156, v157
    v_permlane16_swap_b32 v196, v197
    v_max_f32 v156, v156, v157
    v_max_f32 v196, v196, v197
    v_pk_add_f32 v[152:153], v[152:153], v[156:157] op_sel_hi:[1,0] neg_lo:[0,1] neg_hi:[0,1]
    v_pk_add_f32 v[192:193], v[192:193], v[196:197] op_sel_hi:[1,0] neg_lo:[0,1] neg_hi:[0,1]
    v_pk_add_f32 v[154:155], v[154:155], v[156:157] op_sel_hi:[1,0] neg_lo:[0,1] neg_hi:[0,1]
    v_pk_add_f32 v[194:195], v[194:195], v[196:197] op_sel_hi:[1,0] neg_lo:[0,1] neg_hi:[0,1]
    v_exp_f32 v152, v152
    v_exp_f32 v192, v192
    v_exp_f32 v153, v153
    v_exp_f32 v193, v193
    v_exp_f32 v154, v154
    v_exp_f32 v194, v194
    v_exp_f32 v155, v155
    v_exp_f32 v195, v195
    v_cvt_pk_bf16_f32 v156, v152, v153
    v_cvt_pk_bf16_f32 v196, v192, v193
    v_cvt_pk_bf16_f32 v157, v154, v155
    v_cvt_pk_bf16_f32 v197, v194, v195
    v_and_b32 v158, v48, v156
    v_and_b32 v198, v48, v196
    v_and_b32 v159, v49, v157
    v_and_b32 v199, v49, v197
    v_and_b32 v160, v50, v156
    v_and_b32 v200, v50, v196
    v_and_b32 v161, v51, v157
    v_and_b32 v201, v51, v197
    s_waitcnt lgkmcnt(4)
    s_waitcnt lgkmcnt(0)
    v_mfma_f32_16x16x32_bf16 v[128:131], v[52:55], v[158:161], 0
    v_mfma_f32_16x16x32_bf16 v[168:171], v[52:55], v[198:201], 0
    v_mfma_f32_16x16x32_bf16 v[148:151], v[140:143], v[158:161], 0
    v_mfma_f32_16x16x32_bf16 v[188:191], v[180:183], v[198:201], 0
    v_mfma_f32_16x16x32_bf16 v[152:155], v[144:147], v[158:161], 0
    v_mfma_f32_16x16x32_bf16 v[192:195], v[184:187], v[198:201], 0
    s_nop 2
    v_rcp_f32 v156, v128
    v_rcp_f32 v196, v168
    v_pk_mul_f32 v[148:149], v[148:149], v[156:157] op_sel_hi:[1,0]
    v_pk_mul_f32 v[188:189], v[188:189], v[196:197] op_sel_hi:[1,0]
    v_pk_mul_f32 v[150:151], v[150:151], v[156:157] op_sel_hi:[1,0]
    v_pk_mul_f32 v[190:191], v[190:191], v[196:197] op_sel_hi:[1,0]
    v_pk_mul_f32 v[152:153], v[152:153], v[156:157] op_sel_hi:[1,0]
    v_pk_mul_f32 v[192:193], v[192:193], v[196:197] op_sel_hi:[1,0]
    v_pk_mul_f32 v[154:155], v[154:155], v[156:157] op_sel_hi:[1,0]
    v_pk_mul_f32 v[194:195], v[194:195], v[196:197] op_sel_hi:[1,0]
    v_cvt_pk_bf16_f32 v158, v148, v149
    v_cvt_pk_bf16_f32 v198, v188, v189
    v_cvt_pk_bf16_f32 v159, v150, v151
    v_cvt_pk_bf16_f32 v199, v190, v191
    v_cvt_pk_bf16_f32 v160, v152, v153
    v_cvt_pk_bf16_f32 v200, v192, v193
    v_cvt_pk_bf16_f32 v161, v154, v155
    v_cvt_pk_bf16_f32 v201, v194, v195
    buffer_store_dwordx4 v[158:161], v3, s[28:31], s70 offen offset:0 sc1
    buffer_store_dwordx4 v[198:201], v3, s[28:31], s70 offen offset:256 sc1
P2_TAIL:
    s_lshr_b32 s73, s91, 11
    s_mov_b32 s55, 1073741824
    s_cmp_ge_u32 s73, 6
    s_cselect_b32 s56, 18, 19
    s_cmp_lt_u32 s73, 2
    s_cselect_b32 s56, 16, s56
    s_cmp_gt_u32 s56, 16
    s_cselect_b32 s57, 157696, s55
    s_add_u32 s70, s90, s57
    s_cmp_gt_u32 s56, 17
    s_cselect_b32 s57, 172032, s55
    s_add_u32 s71, s90, s57
    s_cmp_gt_u32 s56, 18
    s_cselect_b32 s57, 186368, s55
    s_add_u32 s72, s90, s57
    s_mul_i32 s78, s78, 1664525
    s_add_u32 s78, s78, 1013904223
    s_lshr_b32 s60, s2, 7
    s_lshl_b32 s60, s60, 3
    s_add_u32 s60, s60, s45
    s_lshl_b32 s60, s60, 2
    s_lshl_b32 s75, s44, 7
    s_add_u32 s75, s75, s60
    s_add_u32 s75, s75, 9437184
    v_mov_b32 v20, s78
    v_mov_b32 v21, 0
    s_waitcnt lgkmcnt(0)
    s_barrier
    s_cmp_ge_u32 s2, 224
    s_cbranch_scc1 P2_NOTILE
    s_waitcnt vmcnt(0)
    s_barrier
    s_cmp_lg_u32 s3, 0
    s_cbranch_scc1 P2_NOFLAG
    s_mov_b64 exec, 1
    buffer_store_dword v20, v21, s[28:31], s75 offen sc1
    s_mov_b64 exec, -1
P2_NOFLAG:
    s_add_u32 m0, s91, 49152
    s_nop 0
    buffer_load_dwordx4 v252, s[92:95], s90 offen lds
    buffer_load_dwordx4 v254, s[92:95], s90 offen offset:1024 lds
    s_add_u32 s90, s90, s96
    s_cmp_ge_u32 s73, 6
    s_cselect_b32 s52, 18, 19
    s_lshl_b32 s60, s73, 4
    s_add_u32 s61, s99, 32
    s_cmp_lt_u32 s73, 2
    s_cselect_b32 s52, 16, s52
    s_cselect_b32 s60, s60, s61
    s_mul_i32 s53, s97, 288
    s_add_u32 s53, s53, s60
    s_lshl_b32 s53, s53, 10
    s_add_u32 s54, s53, 147456
    v_lshlrev_b32 v1, 4, v0
    s_mov_b32 s28, s16
    s_mov_b32 s29, s17
    s_mov_b32 s30, 9441280
    s_mov_b32 s31, 0x20000
    v_lshrrev_b32 v32, 5, v0
    v_lshlrev_b32 v32, 2, v32
    v_bfe_u32 v33, v0, 2, 2
    v_add_u32 v32, v32, v33
    s_add_u32 m0, s91, 65536
    s_nop 0
    buffer_load_dwordx4 v252, s[92:95], s90 offen lds
    buffer_load_dwordx4 v253, s[92:95], s90 offen offset:1024 lds
    s_add_u32 s90, s90, 14336
    v_lshlrev_b32 v32, 7, v32
    v_bfe_u32 v33, v0, 4, 1
    v_lshlrev_b32 v33, 5, v33
    v_and_b32 v5, 3, v0
    v_lshl_add_u32 v33, v5, 3, v33
    v_bfe_u32 v5, v0, 3, 1
    v_lshlrev_b32 v5, 6, v5
    v_xor_b32 v33, v33, v5
    v_add_u32 v5, v32, v33
    v_add_u32 v5, s91, v5
    v_xor_b32 v6, 64, v5
    v_add_u32 v7, 65536, v5
    v_add_u32 v8, 65536, v6
    v_add_u32 v9, 131072, v5
    v_add_u32 v10, 131072, v6
    s_cmp_gt_u32 s52, 16
    s_cselect_b32 s60, 16384, s55
    s_add_u32 s64, s53, s60
    s_add_u32 s65, s54, s60
    s_cmp_gt_u32 s52, 17
    s_cselect_b32 s60, 17408, s55
    s_add_u32 m0, s91, 81920
    s_nop 0
    buffer_load_dwordx4 v252, s[92:95], s90 offen lds
    buffer_load_dwordx4 v254, s[92:95], s90 offen offset:1024 lds
    s_add_u32 s90, s90, s96
    s_add_u32 s66, s53, s60
    s_add_u32 s67, s54, s60
    s_cmp_gt_u32 s52, 18
    s_cselect_b32 s60, 18432, s55
    s_add_u32 s68, s53, s60
    s_add_u32 s69, s54, s60
    s_lshl_b32 s60, s97, 6
    s_lshl_b32 s61, s3, 3
    s_add_u32 s60, s60, s61
    s_mul_i32 s59, s60, 896
    s_lshl_b32 s61, s98, 7
    s_add_u32 s59, s59, s61
    v_lshrrev_b32 v32, 3, v0
    v_and_b32 v33, 7, v0
    v_mul_u32_u24 v11, 896, v32
    v_lshl_add_u32 v11, v33, 4, v11
    s_mov_b32 s20, s4
    s_mov_b32 s21, s5
    s_mov_b32 s22, 1835008
    s_mov_b32 s23, 0x20000
    s_add_u32 m0, s91, 98304
    s_nop 0
    buffer_load_dwordx4 v252, s[92:95], s90 offen lds
    buffer_load_dwordx4 v253, s[92:95], s90 offen offset:1024 lds
    s_add_u32 s90, s90, 14336
    s_mov_b32 s36, s18
    s_mov_b32 s37, s19
    s_mov_b32 s38, 1835008
    s_mov_b32 s39, 0x20000
    v_and_b32 v32, 15, v0
    v_lshlrev_b32 v32, 1, v32
    v_bfe_u32 v33, v0, 4, 1
    v_add_u32 v32, v32, v33
    v_lshrrev_b32 v33, 3, v32
    v_lshlrev_b32 v33, 14, v33
    v_and_b32 v32, 7, v32
    v_lshl_add_u32 v33, v32, 8, v33
    v_lshrrev_b32 v32, 5, v0
    v_and_b32 v34, 7, v0
    v_xor_b32 v32, v32, v34
    v_lshl_add_u32 v33, v32, 4, v33
    v_add_u32 v12, s91, v33
    v_xor_b32 v13, 32, v12
    v_xor_b32 v14, 64, v12
    v_xor_b32 v15, 96, v12
    s_add_u32 m0, s91, 147456
    s_nop 0
    buffer_load_dwordx4 v252, s[92:95], s90 offen lds
    buffer_load_dwordx4 v254, s[92:95], s90 offen offset:1024 lds
    s_add_u32 s90, s90, s96
    v_add_u32 v28, 65536, v12
    v_add_u32 v29, 65536, v13
    v_add_u32 v30, 65536, v14
    v_add_u32 v31, 65536, v15
    v_lshrrev_b32 v32, 3, v0
    v_and_b32 v33, 7, v0
    v_lshlrev_b32 v33, 1, v33
    v_lshrrev_b32 v34, 1, v32
    s_and_b32 s60, s3, 1
    s_lshl_b32 s60, s60, 2
    v_add_u32 v34, s60, v34
    v_xor_b32 v33, v33, v34
    v_lshlrev_b32 v33, 4, v33
    v_lshl_add_u32 v33, v32, 8, v33
    s_lshl_b32 s60, s3, 14
    v_add_u32 v16, s60, v33
    v_xor_b32 v17, 16, v16
    v_mov_b32 v18, 0x3f317218
    ds_read_b64_tr_b16 v[96:97], v5 offset:16384
    ds_read_b64_tr_b16 v[98:99], v5 offset:17408
    ds_read_b64_tr_b16 v[100:101], v6 offset:16384
    ds_read_b64_tr_b16 v[102:103], v6 offset:17408
    ds_read_b64_tr_b16 v[104:105], v5 offset:32768
    ds_read_b64_tr_b16 v[106:107], v5 offset:33792
    ds_read_b64_tr_b16 v[108:109], v6 offset:32768
    ds_read_b64_tr_b16 v[110:111], v6 offset:33792
    s_waitcnt lgkmcnt(4)
    s_add_u32 m0, s91, 16384
    s_nop 0
    buffer_load_dwordx4 v252, s[92:95], s90 offen lds
    buffer_load_dwordx4 v253, s[92:95], s90 offen offset:1024 lds
    s_add_u32 s90, s90, 14336
    ds_read_b64_tr_b16 v[192:193], v7 offset:49152
    ds_read_b64_tr_b16 v[194:195], v7 offset:50176
    ds_read_b64_tr_b16 v[196:197], v8 offset:49152
    ds_read_b64_tr_b16 v[198:199], v8 offset:50176
    s_waitcnt lgkmcnt(4)
    s_add_u32 m0, s91, 32768
    s_nop 0
    buffer_load_dwordx4 v252, s[92:95], s90 offen lds
    buffer_load_dwordx4 v254, s[92:95], s90 offen offset:1024 lds
    s_add_u32 s90, s90, s96
    ds_read_b64_tr_b16 v[200:201], v9 offset:0
    ds_read_b64_tr_b16 v[202:203], v9 offset:1024
    ds_read_b64_tr_b16 v[204:205], v10 offset:0
    ds_read_b64_tr_b16 v[206:207], v10 offset:1024
    s_waitcnt lgkmcnt(4)
    s_add_u32 m0, s91, 114688
    s_nop 0
    buffer_load_dwordx4 v252, s[92:95], s90 offen lds
    buffer_load_dwordx4 v253, s[92:95], s90 offen offset:1024 lds
    s_add_u32 s90, s90, 14336
    ds_read_b64_tr_b16 v[208:209], v5 offset:0
    ds_read_b64_tr_b16 v[210:211], v5 offset:1024
    ds_read_b64_tr_b16 v[212:213], v6 offset:0
    ds_read_b64_tr_b16 v[214:215], v6 offset:1024
    s_waitcnt lgkmcnt(4)
    s_add_u32 m0, s91, 131072
    s_nop 0
    buffer_load_dwordx4 v252, s[92:95], s90 offen lds
    buffer_load_dwordx4 v254, s[92:95], s90 offen offset:1024 lds
    s_add_u32 s90, s90, s96
    s_waitcnt vmcnt(16)
    ds_read_b64_tr_b16 v[216:217], v5 offset:49152
    ds_read_b64_tr_b16 v[218:219], v5 offset:50176
    ds_read_b64_tr_b16 v[220:221], v6 offset:49152
    ds_read_b64_tr_b16 v[222:223], v6 offset:50176
    s_waitcnt lgkmcnt(4)
    s_add_u32 m0, s91, 0
    s_nop 0
    buffer_load_dwordx4 v252, s[92:95], s90 offen lds
    buffer_load_dwordx4 v253, s[92:95], s90 offen offset:1024 lds
    s_add_u32 s90, s90, 14336
    s_waitcnt vmcnt(16)
    ds_read_b64_tr_b16 v[224:225], v7 offset:0
    ds_read_b64_tr_b16 v[226:227], v7 offset:1024
    ds_read_b64_tr_b16 v[228:229], v8 offset:0
    ds_read_b64_tr_b16 v[230:231], v8 offset:1024
    s_waitcnt lgkmcnt(4)
    s_add_u32 m0, s91, 49152
    s_nop 0
    buffer_load_dwordx4 v252, s[92:95], s90 offen lds
    buffer_load_dwordx4 v254, s[92:95], s90 offen offset:1024 lds
    s_waitcnt vmcnt(16)
    ds_read_b64_tr_b16 v[232:233], v7 offset:16384
    ds_read_b64_tr_b16 v[234:235], v7 offset:17408
    ds_read_b64_tr_b16 v[236:237], v8 offset:16384
    ds_read_b64_tr_b16 v[238:239], v8 offset:17408
    s_waitcnt lgkmcnt(4)
    s_waitcnt vmcnt(14)
    ds_read_b64_tr_b16 v[240:241], v7 offset:32768
    ds_read_b64_tr_b16 v[242:243], v7 offset:33792
    ds_read_b64_tr_b16 v[244:245], v8 offset:32768
    ds_read_b64_tr_b16 v[246:247], v8 offset:33792
    s_waitcnt lgkmcnt(4)
    s_cmp_le_u32 s56, 16
    s_cbranch_scc1 P2_NOW16_1
    s_add_u32 m0, s91, 65536
    s_nop 0
    buffer_load_dwordx4 v252, s[92:95], s70 offen lds
    buffer_load_dwordx4 v253, s[92:95], s70 offen offset:1024 lds
    s_add_u32 m0, s91, 81920
    s_nop 0
    buffer_load_dwordx4 v252, s[92:95], s71 offen lds
    buffer_load_dwordx4 v254, s[92:95], s71 offen offset:1024 lds
P2_NOW16_1:
    s_waitcnt lgkmcnt(0)
    s_cmp_le_u32 s56, 18
    s_cbranch_scc1 P2_NOW18_1
    s_add_u32 m0, s91, 98304
    s_nop 0
    buffer_load_dwordx4 v252, s[92:95], s72 offen lds
    buffer_load_dwordx4 v253, s[92:95], s72 offen offset:1024 lds
P2_NOW18_1:
    buffer_load_dwordx4 v[24:27], v11, s[20:23], s59 offen
    s_cmp_lg_u32 s3, 0
    s_cbranch_scc1 P2_GO
    s_lshr_b32 s76, s97, 1
    s_lshl_b32 s76, s76, 7
    s_add_u32 s76, s76, 9437184
    v_and_b32 v22, 15, v0
    v_lshlrev_b32 v22, 2, v22
    s_mov_b32 s77, 20000
P2_POLL:
    buffer_load_dword v23, v22, s[28:31], s76 offen sc1
    s_sub_u32 s77, s77, 1
    s_waitcnt vmcnt(0)
    v_cmp_ne_u32 vcc, s78, v23
    s_cmp_eq_u32 s77, 0
    s_cbranch_scc1 P2_GO
    s_cbranch_vccnz P2_POLL
P2_GO:
    s_barrier
    buffer_load_dwordx4 v[32:35], v1, s[28:31], s53 offen offset:0
    buffer_load_dwordx4 v[36:39], v1, s[28:31], s54 offen offset:0
    buffer_load_dwordx4 v[40:43], v1, s[28:31], s53 offen offset:1024
    buffer_load_dwordx4 v[44:47], v1, s[28:31], s54 offen offset:1024
    buffer_load_dwordx4 v[48:51], v1, s[28:31], s53 offen offset:2048
    buffer_load_dwordx4 v[52:55], v1, s[28:31], s54 offen offset:2048
    buffer_load_dwordx4 v[56:59], v1, s[28:31], s53 offen offset:3072
    buffer_load_dwordx4 v[60:63], v1, s[28:31], s54 offen offset:3072
    s_waitcnt vmcnt(6)
    v_mfma_f32_32x32x16_bf16 v[112:127], v[96:99], v[32:35], 0
    v_mfma_f32_32x32x16_bf16 v[128:143], v[100:103], v[32:35], 0
    v_mfma_f32_32x32x16_bf16 v[144:159], v[96:99], v[36:39], 0
    v_mfma_f32_32x32x16_bf16 v[160:175], v[100:103], v[36:39], 0
    s_add_u32 s53, s53, 4096
    s_add_u32 s54, s54, 4096
    buffer_load_dwordx4 v[64:67], v1, s[28:31], s53 offen offset:0
    buffer_load_dwordx4 v[68:71], v1, s[28:31], s54 offen offset:0
    s_waitcnt vmcnt(6)
    v_mfma_f32_32x32x16_bf16 v[112:127], v[104:107], v[40:43], v[112:127]
    v_mfma_f32_32x32x16_bf16 v[128:143], v[108:111], v[40:43], v[128:143]
    v_mfma_f32_32x32x16_bf16 v[144:159], v[104:107], v[44:47], v[144:159]
    v_mfma_f32_32x32x16_bf16 v[160:175], v[108:111], v[44:47], v[160:175]
    buffer_load_dwordx4 v[72:75], v1, s[28:31], s53 offen offset:1024
    buffer_load_dwordx4 v[76:79], v1, s[28:31], s54 offen offset:1024
    s_waitcnt vmcnt(6)
    v_mfma_f32_32x32x16_bf16 v[112:127], v[192:195], v[48:51], v[112:127]
    v_mfma_f32_32x32x16_bf16 v[128:143], v[196:199], v[48:51], v[128:143]
    v_mfma_f32_32x32x16_bf16 v[144:159], v[192:195], v[52:55], v[144:159]
    v_mfma_f32_32x32x16_bf16 v[160:175], v[196:199], v[52:55], v[160:175]
    buffer_load_dwordx4 v[80:83], v1, s[28:31], s53 offen offset:2048
    buffer_load_dwordx4 v[84:87], v1, s[28:31], s54 offen offset:2048
    s_waitcnt vmcnt(6)
    v_mfma_f32_32x32x16_bf16 v[112:127], v[200:203], v[56:59], v[112:127]
    v_mfma_f32_32x32x16_bf16 v[128:143], v[204:207], v[56:59], v[128:143]
    v_mfma_f32_32x32x16_bf16 v[144:159], v[200:203], v[60:63], v[144:159]
    v_mfma_f32_32x32x16_bf16 v[160:175], v[204:207], v[60:63], v[160:175]
    buffer_load_dwordx4 v[88:91], v1, s[28:31], s53 offen offset:3072
    buffer_load_dwordx4 v[92:95], v1, s[28:31], s54 offen offset:3072
    s_waitcnt vmcnt(6)
    v_mfma_f32_32x32x16_bf16 v[112:127], v[208:211], v[64:67], v[112:127]
    v_mfma_f32_32x32x16_bf16 v[128:143], v[212:215], v[64:67], v[128:143]
    v_mfma_f32_32x32x16_bf16 v[144:159], v[208:211], v[68:71], v[144:159]
    v_mfma_f32_32x32x16_bf16 v[160:175], v[212:215], v[68:71], v[160:175]
    s_add_u32 s53, s53, 4096
    s_add_u32 s54, s54, 4096
    buffer_load_dwordx4 v[32:35], v1, s[28:31], s53 offen offset:0
    buffer_load_dwordx4 v[36:39], v1, s[28:31], s54 offen offset:0
    s_waitcnt vmcnt(6)
    v_mfma_f32_32x32x16_bf16 v[112:127], v[216:219], v[72:75], v[112:127]
    v_mfma_f32_32x32x16_bf16 v[128:143], v[220:223], v[72:75], v[128:143]
    v_mfma_f32_32x32x16_bf16 v[144:159], v[216:219], v[76:79], v[144:159]
    v_mfma_f32_32x32x16_bf16 v[160:175], v[220:223], v[76:79], v[160:175]
    buffer_load_dwordx4 v[40:43], v1, s[28:31], s53 offen offset:1024
    buffer_load_dwordx4 v[44:47], v1, s[28:31], s54 offen offset:1024
    s_waitcnt vmcnt(6)
    v_mfma_f32_32x32x16_bf16 v[112:127], v[224:227], v[80:83], v[112:127]
    v_mfma_f32_32x32x16_bf16 v[128:143], v[228:231], v[80:83], v[128:143]
    v_mfma_f32_32x32x16_bf16 v[144:159], v[224:227], v[84:87], v[144:159]
    v_mfma_f32_32x32x16_bf16 v[160:175], v[228:231], v[84:87], v[160:175]
    buffer_load_dwordx4 v[48:51], v1, s[28:31], s53 offen offset:2048
    buffer_load_dwordx4 v[52:55], v1, s[28:31], s54 offen offset:2048
    s_waitcnt vmcnt(6)
    ds_read_b64_tr_b16 v[176:177], v9 offset:16384
    ds_read_b64_tr_b16 v[178:179], v9 offset:17408
    ds_read_b64_tr_b16 v[180:181], v10 offset:16384
    ds_read_b64_tr_b16 v[182:183], v10 offset:17408
    v_mfma_f32_32x32x16_bf16 v[112:127], v[232:235], v[88:91], v[112:127]
    v_mfma_f32_32x32x16_bf16 v[128:143], v[236:239], v[88:91], v[128:143]
    v_mfma_f32_32x32x16_bf16 v[144:159], v[232:235], v[92:95], v[144:159]
    v_mfma_f32_32x32x16_bf16 v[160:175], v[236:239], v[92:95], v[160:175]
    buffer_load_dwordx4 v[56:59], v1, s[28:31], s53 offen offset:3072
    buffer_load_dwordx4 v[60:63], v1, s[28:31], s54 offen offset:3072
    s_cmp_eq_u32 s52, 18
    s_cbranch_scc1 P2_N18
    s_cmp_eq_u32 s52, 16
    s_cbranch_scc1 P2_N16
    s_waitcnt vmcnt(6)
    ds_read_b64_tr_b16 v[184:185], v5 offset:16384
    ds_read_b64_tr_b16 v[186:187], v5 offset:17408
    ds_read_b64_tr_b16 v[188:189], v6 offset:16384
    ds_read_b64_tr_b16 v[190:191], v6 offset:17408
    v_mfma_f32_32x32x16_bf16 v[112:127], v[240:243], v[32:35], v[112:127]
    v_mfma_f32_32x32x16_bf16 v[128:143], v[244:247], v[32:35], v[128:143]
    v_mfma_f32_32x32x16_bf16 v[144:159], v[240:243], v[36:39], v[144:159]
    v_mfma_f32_32x32x16_bf16 v[160:175], v[244:247], v[36:39], v[160:175]
    s_add_u32 s53, s53, 4096
    s_add_u32 s54, s54, 4096
    buffer_load_dwordx4 v[64:67], v1, s[28:31], s53 offen offset:0
    buffer_load_dwordx4 v[68:71], v1, s[28:31], s54 offen offset:0
    s_waitcnt vmcnt(6)
    s_waitcnt lgkmcnt(4)
    ds_read_b64_tr_b16 v[96:97], v5 offset:32768
    ds_read_b64_tr_b16 v[98:99], v5 offset:33792
    ds_read_b64_tr_b16 v[100:101], v6 offset:32768
    ds_read_b64_tr_b16 v[102:103], v6 offset:33792
    v_mfma_f32_32x32x16_bf16 v[112:127], v[176:179], v[40:43], v[112:127]
    v_mfma_f32_32x32x16_bf16 v[128:143], v[180:183], v[40:43], v[128:143]
    v_mfma_f32_32x32x16_bf16 v[144:159], v[176:179], v[44:47], v[144:159]
    v_mfma_f32_32x32x16_bf16 v[160:175], v[180:183], v[44:47], v[160:175]
    buffer_load_dwordx4 v[72:75], v1, s[28:31], s53 offen offset:1024
    buffer_load_dwordx4 v[76:79], v1, s[28:31], s54 offen offset:1024
    s_waitcnt vmcnt(6)
    s_waitcnt lgkmcnt(4)
    ds_read_b64_tr_b16 v[104:105], v7 offset:49152
    ds_read_b64_tr_b16 v[106:107], v7 offset:50176
    ds_read_b64_tr_b16 v[108:109], v8 offset:49152
    ds_read_b64_tr_b16 v[110:111], v8 offset:50176
    v_mfma_f32_32x32x16_bf16 v[112:127], v[184:187], v[48:51], v[112:127]
    v_mfma_f32_32x32x16_bf16 v[128:143], v[188:191], v[48:51], v[128:143]
    v_mfma_f32_32x32x16_bf16 v[144:159], v[184:187], v[52:55], v[144:159]
    v_mfma_f32_32x32x16_bf16 v[160:175], v[188:191], v[52:55], v[160:175]
    buffer_load_dwordx4 v[80:83], v1, s[28:31], s53 offen offset:2048
    buffer_load_dwordx4 v[84:87], v1, s[28:31], s54 offen offset:2048
    s_waitcnt vmcnt(6)
    s_waitcnt lgkmcnt(4)
    ds_read_b64_tr_b16 v[192:193], v9 offset:0
    ds_read_b64_tr_b16 v[194:195], v9 offset:1024
    ds_read_b64_tr_b16 v[196:197], v10 offset:0
    ds_read_b64_tr_b16 v[198:199], v10 offset:1024
    v_mfma_f32_32x32x16_bf16 v[112:127], v[96:99], v[56:59], v[112:127]
    v_mfma_f32_32x32x16_bf16 v[128:143], v[100:103], v[56:59], v[128:143]
    v_mfma_f32_32x32x16_bf16 v[144:159], v[96:99], v[60:63], v[144:159]
    v_mfma_f32_32x32x16_bf16 v[160:175], v[100:103], v[60:63], v[160:175]
    buffer_load_dwordx4 v[88:91], v1, s[28:31], s53 offen offset:3072
    buffer_load_dwordx4 v[92:95], v1, s[28:31], s54 offen offset:3072
    s_waitcnt vmcnt(6)
    s_waitcnt lgkmcnt(4)
    ds_read_b64_tr_b16 v[200:201], v5 offset:0
    ds_read_b64_tr_b16 v[202:203], v5 offset:1024
    ds_read_b64_tr_b16 v[204:205], v6 offset:0
    ds_read_b64_tr_b16 v[206:207], v6 offset:1024
    v_mfma_f32_32x32x16_bf16 v[112:127], v[104:107], v[64:67], v[112:127]
    v_mfma_f32_32x32x16_bf16 v[128:143], v[108:111], v[64:67], v[128:143]
    v_mfma_f32_32x32x16_bf16 v[144:159], v[104:107], v[68:71], v[144:159]
    v_mfma_f32_32x32x16_bf16 v[160:175], v[108:111], v[68:71], v[160:175]
    buffer_load_dwordx4 v[32:35], v1, s[28:31], s64 offen offset:0
    buffer_load_dwordx4 v[36:39], v1, s[28:31], s65 offen offset:0
    s_waitcnt vmcnt(6)
    s_waitcnt lgkmcnt(4)
    ds_read_b64_tr_b16 v[208:209], v5 offset:49152
    ds_read_b64_tr_b16 v[210:211], v5 offset:50176
    ds_read_b64_tr_b16 v[212:213], v6 offset:49152
    ds_read_b64_tr_b16 v[214:215], v6 offset:50176
    v_mfma_f32_32x32x16_bf16 v[112:127], v[192:195], v[72:75], v[112:127]
    v_mfma_f32_32x32x16_bf16 v[128:143], v[196:199], v[72:75], v[128:143]
    buffer_load_dwordx4 v[40:43], v1, s[28:31], s66 offen offset:0
    buffer_load_dwordx4 v[44:47], v1, s[28:31], s67 offen offset:0
    s_waitcnt vmcnt(6)
    s_waitcnt lgkmcnt(4)
    ds_read_b64_tr_b16 v[216:217], v7 offset:0
    ds_read_b64_tr_b16 v[218:219], v7 offset:1024
    ds_read_b64_tr_b16 v[220:221], v8 offset:0
    ds_read_b64_tr_b16 v[222:223], v8 offset:1024
    v_mfma_f32_32x32x16_bf16 v[112:127], v[200:203], v[80:83], v[112:127]
    v_mfma_f32_32x32x16_bf16 v[128:143], v[204:207], v[80:83], v[128:143]
    buffer_load_dwordx4 v[48:51], v1, s[28:31], s68 offen offset:0
    buffer_load_dwordx4 v[52:55], v1, s[28:31], s69 offen offset:0
    s_waitcnt vmcnt(6)
    s_waitcnt lgkmcnt(4)
    ds_read_b64_tr_b16 v[224:225], v7 offset:16384
    ds_read_b64_tr_b16 v[226:227], v7 offset:17408
    ds_read_b64_tr_b16 v[228:229], v8 offset:16384
    ds_read_b64_tr_b16 v[230:231], v8 offset:17408
    v_mfma_f32_32x32x16_bf16 v[112:127], v[208:211], v[88:91], v[112:127]
    v_mfma_f32_32x32x16_bf16 v[128:143], v[212:215], v[88:91], v[128:143]
    s_waitcnt vmcnt(4)
    s_waitcnt lgkmcnt(4)
    ds_read_b64_tr_b16 v[232:233], v7 offset:32768
    ds_read_b64_tr_b16 v[234:235], v7 offset:33792
    ds_read_b64_tr_b16 v[236:237], v8 offset:32768
    ds_read_b64_tr_b16 v[238:239], v8 offset:33792
    v_mfma_f32_32x32x16_bf16 v[112:127], v[216:219], v[32:35], v[112:127]
    v_mfma_f32_32x32x16_bf16 v[128:143], v[220:223], v[32:35], v[128:143]
    s_waitcnt vmcnt(2)
    s_waitcnt lgkmcnt(4)
    v_mfma_f32_32x32x16_bf16 v[112:127], v[224:227], v[40:43], v[112:127]
    v_mfma_f32_32x32x16_bf16 v[128:143], v[228:231], v[40:43], v[128:143]
    s_waitcnt vmcnt(0)
    s_waitcnt lgkmcnt(0)
    v_mfma_f32_32x32x16_bf16 v[112:127], v[232:235], v[48:51], v[112:127]
    v_mfma_f32_32x32x16_bf16 v[128:143], v[236:239], v[48:51], v[128:143]
    v_mfma_f32_32x32x16_bf16 v[144:159], v[192:195], v[76:79], v[144:159]
    v_mfma_f32_32x32x16_bf16 v[160:175], v[196:199], v[76:79], v[160:175]
    v_mfma_f32_32x32x16_bf16 v[144:159], v[200:203], v[84:87], v[144:159]
    s_nop 7
    ds_write_b128 v12, v[112:115] offset:0
    v_mfma_f32_32x32x16_bf16 v[160:175], v[204:207], v[84:87], v[160:175]
    ds_write_b128 v13, v[116:119] offset:0
    v_mfma_f32_32x32x16_bf16 v[144:159], v[208:211], v[92:95], v[144:159]
    ds_write_b128 v14, v[120:123] offset:0
    v_mfma_f32_32x32x16_bf16 v[160:175], v[212:215], v[92:95], v[160:175]
    ds_write_b128 v15, v[124:127] offset:0
    v_mfma_f32_32x32x16_bf16 v[144:159], v[216:219], v[36:39], v[144:159]
    ds_write_b128 v12, v[128:131] offset:128
    v_mfma_f32_32x32x16_bf16 v[160:175], v[220:223], v[36:39], v[160:175]
    ds_write_b128 v13, v[132:135] offset:128
    v_mfma_f32_32x32x16_bf16 v[144:159], v[224:227], v[44:47], v[144:159]
    ds_write_b128 v14, v[136:139] offset:128
    v_mfma_f32_32x32x16_bf16 v[160:175], v[228:231], v[44:47], v[160:175]
    ds_write_b128 v15, v[140:143] offset:128
    v_mfma_f32_32x32x16_bf16 v[144:159], v[232:235], v[52:55], v[144:159]
    v_mfma_f32_32x32x16_bf16 v[160:175], v[236:239], v[52:55], v[160:175]
    s_nop 10
    ds_write_b128 v28, v[144:147] offset:0
    ds_write_b128 v29, v[148:151] offset:0
    ds_write_b128 v30, v[152:155] offset:0
    ds_write_b128 v31, v[156:159] offset:0
    ds_write_b128 v28, v[160:163] offset:128
    ds_write_b128 v29, v[164:167] offset:128
    ds_write_b128 v30, v[168:171] offset:128
    ds_write_b128 v31, v[172:175] offset:128
    s_branch P2_RED
P2_N18:
    s_waitcnt vmcnt(6)
    ds_read_b64_tr_b16 v[184:185], v5 offset:16384
    ds_read_b64_tr_b16 v[186:187], v5 offset:17408
    ds_read_b64_tr_b16 v[188:189], v6 offset:16384
    ds_read_b64_tr_b16 v[190:191], v6 offset:17408
    v_mfma_f32_32x32x16_bf16 v[112:127], v[240:243], v[32:35], v[112:127]
    v_mfma_f32_32x32x16_bf16 v[128:143], v[244:247], v[32:35], v[128:143]
    v_mfma_f32_32x32x16_bf16 v[144:159], v[240:243], v[36:39], v[144:159]
    v_mfma_f32_32x32x16_bf16 v[160:175], v[244:247], v[36:39], v[160:175]
    s_add_u32 s53, s53, 4096
    s_add_u32 s54, s54, 4096
    buffer_load_dwordx4 v[64:67], v1, s[28:31], s53 offen offset:0
    buffer_load_dwordx4 v[68:71], v1, s[28:31], s54 offen offset:0
    s_waitcnt vmcnt(6)
    s_waitcnt lgkmcnt(4)
    ds_read_b64_tr_b16 v[96:97], v5 offset:32768
    ds_read_b64_tr_b16 v[98:99], v5 offset:33792
    ds_read_b64_tr_b16 v[100:101], v6 offset:32768
    ds_read_b64_tr_b16 v[102:103], v6 offset:33792
    v_mfma_f32_32x32x16_bf16 v[112:127], v[176:179], v[40:43], v[112:127]
    v_mfma_f32_32x32x16_bf16 v[128:143], v[180:183], v[40:43], v[128:143]
    v_mfma_f32_32x32x16_bf16 v[144:159], v[176:179], v[44:47], v[144:159]
    v_mfma_f32_32x32x16_bf16 v[160:175], v[180:183], v[44:47], v[160:175]
    buffer_load_dwordx4 v[72:75], v1, s[28:31], s53 offen offset:1024
    buffer_load_dwordx4 v[76:79], v1, s[28:31], s54 offen offset:1024
    s_waitcnt vmcnt(6)
    s_waitcnt lgkmcnt(4)
    ds_read_b64_tr_b16 v[104:105], v7 offset:49152
    ds_read_b64_tr_b16 v[106:107], v7 offset:50176
    ds_read_b64_tr_b16 v[108:109], v8 offset:49152
    ds_read_b64_tr_b16 v[110:111], v8 offset:50176
    v_mfma_f32_32x32x16_bf16 v[112:127], v[184:187], v[48:51], v[112:127]
    v_mfma_f32_32x32x16_bf16 v[128:143], v[188:191], v[48:51], v[128:143]
    v_mfma_f32_32x32x16_bf16 v[144:159], v[184:187], v[52:55], v[144:159]
    v_mfma_f32_32x32x16_bf16 v[160:175], v[188:191], v[52:55], v[160:175]
    buffer_load_dwordx4 v[80:83], v1, s[28:31], s53 offen offset:2048
    buffer_load_dwordx4 v[84:87], v1, s[28:31], s54 offen offset:2048
    s_waitcnt vmcnt(6)
    s_waitcnt lgkmcnt(4)
    ds_read_b64_tr_b16 v[192:193], v9 offset:0
    ds_read_b64_tr_b16 v[194:195], v9 offset:1024
    ds_read_b64_tr_b16 v[196:197], v10 offset:0
    ds_read_b64_tr_b16 v[198:199], v10 offset:1024
    v_mfma_f32_32x32x16_bf16 v[112:127], v[96:99], v[56:59], v[112:127]
    v_mfma_f32_32x32x16_bf16 v[128:143], v[100:103], v[56:59], v[128:143]
    v_mfma_f32_32x32x16_bf16 v[144:159], v[96:99], v[60:63], v[144:159]
    v_mfma_f32_32x32x16_bf16 v[160:175], v[100:103], v[60:63], v[160:175]
    buffer_load_dwordx4 v[88:91], v1, s[28:31], s53 offen offset:3072
    buffer_load_dwordx4 v[92:95], v1, s[28:31], s54 offen offset:3072
    s_waitcnt vmcnt(6)
    s_waitcnt lgkmcnt(4)
    ds_read_b64_tr_b16 v[200:201], v5 offset:0
    ds_read_b64_tr_b16 v[202:203], v5 offset:1024
    ds_read_b64_tr_b16 v[204:205], v6 offset:0
    ds_read_b64_tr_b16 v[206:207], v6 offset:1024
    v_mfma_f32_32x32x16_bf16 v[112:127], v[104:107], v[64:67], v[112:127]
    v_mfma_f32_32x32x16_bf16 v[128:143], v[108:111], v[64:67], v[128:143]
    buffer_load_dwordx4 v[32:35], v1, s[28:31], s64 offen offset:0
    buffer_load_dwordx4 v[36:39], v1, s[28:31], s65 offen offset:0
    s_waitcnt vmcnt(6)
    s_waitcnt lgkmcnt(4)
    ds_read_b64_tr_b16 v[208:209], v5 offset:49152
    ds_read_b64_tr_b16 v[210:211], v5 offset:50176
    ds_read_b64_tr_b16 v[212:213], v6 offset:49152
    ds_read_b64_tr_b16 v[214:215], v6 offset:50176
    v_mfma_f32_32x32x16_bf16 v[112:127], v[192:195], v[72:75], v[112:127]
    v_mfma_f32_32x32x16_bf16 v[128:143], v[196:199], v[72:75], v[128:143]
    buffer_load_dwordx4 v[40:43], v1, s[28:31], s66 offen offset:0
    buffer_load_dwordx4 v[44:47], v1, s[28:31], s67 offen offset:0
    s_waitcnt vmcnt(6)
    s_waitcnt lgkmcnt(4)
    ds_read_b64_tr_b16 v[216:217], v7 offset:0
    ds_read_b64_tr_b16 v[218:219], v7 offset:1024
    ds_read_b64_tr_b16 v[220:221], v8 offset:0
    ds_read_b64_tr_b16 v[222:223], v8 offset:1024
    v_mfma_f32_32x32x16_bf16 v[112:127], v[200:203], v[80:83], v[112:127]
    v_mfma_f32_32x32x16_bf16 v[128:143], v[204:207], v[80:83], v[128:143]
    s_waitcnt vmcnt(4)
    s_waitcnt lgkmcnt(4)
    ds_read_b64_tr_b16 v[224:225], v7 offset:16384
    ds_read_b64_tr_b16 v[226:227], v7 offset:17408
    ds_read_b64_tr_b16 v[228:229], v8 offset:16384
    ds_read_b64_tr_b16 v[230:231], v8 offset:17408
    v_mfma_f32_32x32x16_bf16 v[112:127], v[208:211], v[88:91], v[112:127]
    v_mfma_f32_32x32x16_bf16 v[128:143], v[212:215], v[88:91], v[128:143]
    s_waitcnt vmcnt(2)
    s_waitcnt lgkmcnt(4)
    v_mfma_f32_32x32x16_bf16 v[112:127], v[216:219], v[32:35], v[112:127]
    v_mfma_f32_32x32x16_bf16 v[128:143], v[220:223], v[32:35], v[128:143]
    s_waitcnt vmcnt(0)
    s_waitcnt lgkmcnt(0)
    v_mfma_f32_32x32x16_bf16 v[112:127], v[224:227], v[40:43], v[112:127]
    v_mfma_f32_32x32x16_bf16 v[128:143], v[228:231], v[40:43], v[128:143]
    v_mfma_f32_32x32x16_bf16 v[144:159], v[104:107], v[68:71], v[144:159]
    v_mfma_f32_32x32x16_bf16 v[160:175], v[108:111], v[68:71], v[160:175]
    v_mfma_f32_32x32x16_bf16 v[144:159], v[192:195], v[76:79], v[144:159]
    s_nop 7
    ds_write_b128 v12, v[112:115] offset:0
    v_mfma_f32_32x32x16_bf16 v[160:175], v[196:199], v[76:79], v[160:175]
    ds_write_b128 v13, v[116:119] offset:0
    v_mfma_f32_32x32x16_bf16 v[144:159], v[200:203], v[84:87], v[144:159]
    ds_write_b128 v14, v[120:123] offset:0
    v_mfma_f32_32x32x16_bf16 v[160:175], v[204:207], v[84:87], v[160:175]
    ds_write_b128 v15, v[124:127] offset:0
    v_mfma_f32_32x32x16_bf16 v[144:159], v[208:211], v[92:95], v[144:159]
    ds_write_b128 v12, v[128:131] offset:128
    v_mfma_f32_32x32x16_bf16 v[160:175], v[212:215], v[92:95], v[160:175]
    ds_write_b128 v13, v[132:135] offset:128
    v_mfma_f32_32x32x16_bf16 v[144:159], v[216:219], v[36:39], v[144:159]
    ds_write_b128 v14, v[136:139] offset:128
    v_mfma_f32_32x32x16_bf16 v[160:175], v[220:223], v[36:39], v[160:175]
    ds_write_b128 v15, v[140:143] offset:128
    v_mfma_f32_32x32x16_bf16 v[144:159], v[224:227], v[44:47], v[144:159]
    v_mfma_f32_32x32x16_bf16 v[160:175], v[228:231], v[44:47], v[160:175]
    s_nop 10
    ds_write_b128 v28, v[144:147] offset:0
    ds_write_b128 v29, v[148:151] offset:0
    ds_write_b128 v30, v[152:155] offset:0
    ds_write_b128 v31, v[156:159] offset:0
    ds_write_b128 v28, v[160:163] offset:128
    ds_write_b128 v29, v[164:167] offset:128
    ds_write_b128 v30, v[168:171] offset:128
    ds_write_b128 v31, v[172:175] offset:128
    s_branch P2_RED
P2_N16:
    s_waitcnt vmcnt(6)
    ds_read_b64_tr_b16 v[184:185], v5 offset:16384
    ds_read_b64_tr_b16 v[186:187], v5 offset:17408
    ds_read_b64_tr_b16 v[188:189], v6 offset:16384
    ds_read_b64_tr_b16 v[190:191], v6 offset:17408
    v_mfma_f32_32x32x16_bf16 v[112:127], v[240:243], v[32:35], v[112:127]
    v_mfma_f32_32x32x16_bf16 v[128:143], v[244:247], v[32:35], v[128:143]
    v_mfma_f32_32x32x16_bf16 v[144:159], v[240:243], v[36:39], v[144:159]
    v_mfma_f32_32x32x16_bf16 v[160:175], v[244:247], v[36:39], v[160:175]
    s_add_u32 s53, s53, 4096
    s_add_u32 s54, s54, 4096
    buffer_load_dwordx4 v[64:67], v1, s[28:31], s53 offen offset:0
    buffer_load_dwordx4 v[68:71], v1, s[28:31], s54 offen offset:0
    s_waitcnt vmcnt(6)
    s_waitcnt lgkmcnt(4)
    ds_read_b64_tr_b16 v[96:97], v5 offset:32768
    ds_read_b64_tr_b16 v[98:99], v5 offset:33792
    ds_read_b64_tr_b16 v[100:101], v6 offset:32768
    ds_read_b64_tr_b16 v[102:103], v6 offset:33792
    v_mfma_f32_32x32x16_bf16 v[112:127], v[176:179], v[40:43], v[112:127]
    v_mfma_f32_32x32x16_bf16 v[128:143], v[180:183], v[40:43], v[128:143]
    v_mfma_f32_32x32x16_bf16 v[144:159], v[176:179], v[44:47], v[144:159]
    v_mfma_f32_32x32x16_bf16 v[160:175], v[180:183], v[44:47], v[160:175]
    buffer_load_dwordx4 v[72:75], v1, s[28:31], s53 offen offset:1024
    buffer_load_dwordx4 v[76:79], v1, s[28:31], s54 offen offset:1024
    s_waitcnt vmcnt(6)
    s_waitcnt lgkmcnt(4)
    ds_read_b64_tr_b16 v[104:105], v7 offset:49152
    ds_read_b64_tr_b16 v[106:107], v7 offset:50176
    ds_read_b64_tr_b16 v[108:109], v8 offset:49152
    ds_read_b64_tr_b16 v[110:111], v8 offset:50176
    v_mfma_f32_32x32x16_bf16 v[112:127], v[184:187], v[48:51], v[112:127]
    v_mfma_f32_32x32x16_bf16 v[128:143], v[188:191], v[48:51], v[128:143]
    buffer_load_dwordx4 v[80:83], v1, s[28:31], s53 offen offset:2048
    buffer_load_dwordx4 v[84:87], v1, s[28:31], s54 offen offset:2048
    s_waitcnt vmcnt(6)
    s_waitcnt lgkmcnt(4)
    ds_read_b64_tr_b16 v[192:193], v9 offset:0
    ds_read_b64_tr_b16 v[194:195], v9 offset:1024
    ds_read_b64_tr_b16 v[196:197], v10 offset:0
    ds_read_b64_tr_b16 v[198:199], v10 offset:1024
    v_mfma_f32_32x32x16_bf16 v[112:127], v[96:99], v[56:59], v[112:127]
    v_mfma_f32_32x32x16_bf16 v[128:143], v[100:103], v[56:59], v[128:143]
    buffer_load_dwordx4 v[88:91], v1, s[28:31], s53 offen offset:3072
    buffer_load_dwordx4 v[92:95], v1, s[28:31], s54 offen offset:3072
    s_waitcnt vmcnt(6)
    s_waitcnt lgkmcnt(4)
    ds_read_b64_tr_b16 v[200:201], v5 offset:0
    ds_read_b64_tr_b16 v[202:203], v5 offset:1024
    ds_read_b64_tr_b16 v[204:205], v6 offset:0
    ds_read_b64_tr_b16 v[206:207], v6 offset:1024
    v_mfma_f32_32x32x16_bf16 v[112:127], v[104:107], v[64:67], v[112:127]
    v_mfma_f32_32x32x16_bf16 v[128:143], v[108:111], v[64:67], v[128:143]
    s_waitcnt vmcnt(4)
    s_waitcnt lgkmcnt(4)
    ds_read_b64_tr_b16 v[208:209], v5 offset:49152
    ds_read_b64_tr_b16 v[210:211], v5 offset:50176
    ds_read_b64_tr_b16 v[212:213], v6 offset:49152
    ds_read_b64_tr_b16 v[214:215], v6 offset:50176
    v_mfma_f32_32x32x16_bf16 v[112:127], v[192:195], v[72:75], v[112:127]
    v_mfma_f32_32x32x16_bf16 v[128:143], v[196:199], v[72:75], v[128:143]
    s_waitcnt vmcnt(2)
    s_waitcnt lgkmcnt(4)
    v_mfma_f32_32x32x16_bf16 v[112:127], v[200:203], v[80:83], v[112:127]
    v_mfma_f32_32x32x16_bf16 v[128:143], v[204:207], v[80:83], v[128:143]
    s_waitcnt vmcnt(0)
    s_waitcnt lgkmcnt(0)
    v_mfma_f32_32x32x16_bf16 v[112:127], v[208:211], v[88:91], v[112:127]
    v_mfma_f32_32x32x16_bf16 v[128:143], v[212:215], v[88:91], v[128:143]
    v_mfma_f32_32x32x16_bf16 v[144:159], v[184:187], v[52:55], v[144:159]
    v_mfma_f32_32x32x16_bf16 v[160:175], v[188:191], v[52:55], v[160:175]
    v_mfma_f32_32x32x16_bf16 v[144:159], v[96:99], v[60:63], v[144:159]
    s_nop 7
    ds_write_b128 v12, v[112:115] offset:0
    v_mfma_f32_32x32x16_bf16 v[160:175], v[100:103], v[60:63], v[160:175]
    ds_write_b128 v13, v[116:119] offset:0
    v_mfma_f32_32x32x16_bf16 v[144:159], v[104:107], v[68:71], v[144:159]
    ds_write_b128 v14, v[120:123] offset:0
    v_mfma_f32_32x32x16_bf16 v[160:175], v[108:111], v[68:71], v[160:175]
    ds_write_b128 v15, v[124:127] offset:0
    v_mfma_f32_32x32x16_bf16 v[144:159], v[192:195], v[76:79], v[144:159]
    ds_write_b128 v12, v[128:131] offset:128
    v_mfma_f32_32x32x16_bf16 v[160:175], v[196:199], v[76:79], v[160:175]
    ds_write_b128 v13, v[132:135] offset:128
    v_mfma_f32_32x32x16_bf16 v[144:159], v[200:203], v[84:87], v[144:159]
    ds_write_b128 v14, v[136:139] offset:128
    v_mfma_f32_32x32x16_bf16 v[160:175], v[204:207], v[84:87], v[160:175]
    ds_write_b128 v15, v[140:143] offset:128
    v_mfma_f32_32x32x16_bf16 v[144:159], v[208:211], v[92:95], v[144:159]
    v_mfma_f32_32x32x16_bf16 v[160:175], v[212:215], v[92:95], v[160:175]
    s_nop 10
    ds_write_b128 v28, v[144:147] offset:0
    ds_write_b128 v29, v[148:151] offset:0
    ds_write_b128 v30, v[152:155] offset:0
    ds_write_b128 v31, v[156:159] offset:0
    ds_write_b128 v28, v[160:163] offset:128
    ds_write_b128 v29, v[164:167] offset:128
    ds_write_b128 v30, v[168:171] offset:128
    ds_write_b128 v31, v[172:175] offset:128
P2_RED:
    s_waitcnt lgkmcnt(0)
    s_barrier
    ds_read_b128 v[32:35], v16 offset:0
    ds_read_b128 v[36:39], v17 offset:0
    ds_read_b128 v[40:43], v16 offset:2048
    ds_read_b128 v[44:47], v17 offset:2048
    ds_read_b128 v[48:51], v16 offset:4096
    ds_read_b128 v[52:55], v17 offset:4096
    ds_read_b128 v[56:59], v16 offset:6144
    ds_read_b128 v[60:63], v17 offset:6144
    ds_read_b128 v[64:67], v16 offset:8192
    ds_read_b128 v[68:71], v17 offset:8192
    ds_read_b128 v[72:75], v16 offset:10240
    ds_read_b128 v[76:79], v17 offset:10240
    ds_read_b128 v[80:83], v16 offset:12288
    ds_read_b128 v[84:87], v17 offset:12288
    ds_read_b128 v[88:91], v16 offset:14336
    ds_read_b128 v[92:95], v17 offset:14336
    s_waitcnt lgkmcnt(8)
    v_pk_add_f32 v[48:49], v[48:49], v[56:57]
    v_pk_add_f32 v[50:51], v[50:51], v[58:59]
    v_pk_add_f32 v[52:53], v[52:53], v[60:61]
    v_pk_add_f32 v[54:55], v[54:55], v[62:63]
    v_pk_add_f32 v[32:33], v[32:33], v[40:41]
    v_pk_add_f32 v[34:35], v[34:35], v[42:43]
    v_pk_add_f32 v[36:37], v[36:37], v[44:45]
    v_pk_add_f32 v[38:39], v[38:39], v[46:47]
    s_waitcnt lgkmcnt(4)
    v_pk_add_f32 v[64:65], v[64:65], v[72:73]
    v_pk_add_f32 v[66:67], v[66:67], v[74:75]
    v_pk_add_f32 v[68:69], v[68:69], v[76:77]
    v_pk_add_f32 v[70:71], v[70:71], v[78:79]
    v_lshlrev_b32 v108, 16, v24
    v_and_b32 v109, 0xffff0000, v24
    v_lshlrev_b32 v110, 16, v25
    v_and_b32 v111, 0xffff0000, v25
    v_lshlrev_b32 v112, 16, v26
    v_and_b32 v113, 0xffff0000, v26
    v_lshlrev_b32 v114, 16, v27
    v_and_b32 v115, 0xffff0000, v27
    s_waitcnt lgkmcnt(0)
    v_pk_add_f32 v[80:81], v[80:81], v[88:89]
    v_pk_add_f32 v[82:83], v[82:83], v[90:91]
    v_pk_add_f32 v[84:85], v[84:85], v[92:93]
    v_pk_add_f32 v[86:87], v[86:87], v[94:95]
    v_pk_add_f32 v[48:49], v[48:49], v[64:65]
    v_pk_add_f32 v[50:51], v[50:51], v[66:67]
    v_pk_add_f32 v[52:53], v[52:53], v[68:69]
    v_pk_add_f32 v[54:55], v[54:55], v[70:71]
    v_pk_add_f32 v[48:49], v[48:49], v[80:81]
    v_pk_add_f32 v[50:51], v[50:51], v[82:83]
    v_pk_add_f32 v[52:53], v[52:53], v[84:85]
    v_pk_add_f32 v[54:55], v[54:55], v[86:87]
    v_exp_f32 v100, -v48
    v_exp_f32 v101, -v49
    v_exp_f32 v102, -v50
    v_exp_f32 v103, -v51
    v_exp_f32 v104, -v52
    v_exp_f32 v105, -v53
    v_exp_f32 v106, -v54
    v_exp_f32 v107, -v55
    v_pk_mul_f32 v[32:33], v[32:33], v[48:49]
    v_pk_mul_f32 v[34:35], v[34:35], v[50:51]
    v_pk_mul_f32 v[36:37], v[36:37], v[52:53]
    v_pk_mul_f32 v[38:39], v[38:39], v[54:55]
    v_add_f32 v100, 1.0, v100
    v_add_f32 v101, 1.0, v101
    v_add_f32 v102, 1.0, v102
    v_add_f32 v103, 1.0, v103
    v_add_f32 v104, 1.0, v104
    v_add_f32 v105, 1.0, v105
    v_add_f32 v106, 1.0, v106
    v_add_f32 v107, 1.0, v107
    v_rcp_f32 v100, v100
    v_rcp_f32 v101, v101
    v_rcp_f32 v102, v102
    v_rcp_f32 v103, v103
    v_rcp_f32 v104, v104
    v_rcp_f32 v105, v105
    v_rcp_f32 v106, v106
    v_rcp_f32 v107, v107
    v_pk_mul_f32 v[32:33], v[32:33], v[100:101]
    v_pk_mul_f32 v[34:35], v[34:35], v[102:103]
    v_pk_mul_f32 v[36:37], v[36:37], v[104:105]
    v_pk_mul_f32 v[38:39], v[38:39], v[106:107]
    v_pk_fma_f32 v[32:33], v[32:33], v[18:19], v[108:109] op_sel_hi:[1,0,1]
    v_pk_fma_f32 v[34:35], v[34:35], v[18:19], v[110:111] op_sel_hi:[1,0,1]
    v_pk_fma_f32 v[36:37], v[36:37], v[18:19], v[112:113] op_sel_hi:[1,0,1]
    v_pk_fma_f32 v[38:39], v[38:39], v[18:19], v[114:115] op_sel_hi:[1,0,1]
    v_cvt_pk_bf16_f32 v100, v32, v33
    v_cvt_pk_bf16_f32 v101, v34, v35
    v_cvt_pk_bf16_f32 v102, v36, v37
    v_cvt_pk_bf16_f32 v103, v38, v39
    buffer_store_dwordx4 v[100:103], v11, s[36:39], s59 offen sc1
    s_endpgm
P2_NOTILE:
    s_waitcnt vmcnt(0)
    s_barrier
    s_cmp_lg_u32 s3, 0
    s_cbranch_scc1 P2_EXIT
    s_mov_b64 exec, 1
    buffer_store_dword v20, v21, s[28:31], s75 offen sc1
    s_mov_b64 exec, -1
    s_cmp_lg_u32 s2, 255
    s_cbranch_scc1 P2_EXIT
    v_lshrrev_b32 v22, 2, v0
    v_lshlrev_b32 v22, 7, v22
    v_and_b32 v23, 3, v0
    v_lshl_add_u32 v22, v23, 4, v22
    s_mov_b32 s76, 9437184
    s_mov_b32 s77, 20000
P2_POLLALL:
    buffer_load_dwordx4 v[24:27], v22, s[28:31], s76 offen sc1
    s_sub_u32 s77, s77, 1
    s_waitcnt vmcnt(0)
    v_xor_b32 v24, s78, v24
    v_xor_b32 v25, s78, v25
    v_xor_b32 v26, s78, v26
    v_xor_b32 v27, s78, v27
    v_or3_b32 v24, v24, v25, v26
    v_or_b32 v24, v24, v27
    v_cmp_ne_u32 vcc, 0, v24
    s_cmp_eq_u32 s77, 0
    s_cbranch_scc1 P2_GEN
    s_cbranch_vccnz P2_POLLALL
P2_GEN:
    s_mov_b32 s76, 9439232
    s_mov_b64 exec, 1
    buffer_store_dword v20, v21, s[28:31], s76 offen sc1
    s_mov_b64 exec, -1
P2_EXIT:
K1_END:
    s_endpgm
CODE_END:
.section .rodata,"a"
.p2align 6
.amdhsa_kernel recurrent_scan__sliding_local_dilated__dense_activation_mish__prompt_kernel
  .amdhsa_next_free_vgpr 256
  .amdhsa_next_free_sgpr 102
  .amdhsa_accum_offset 256
  .amdhsa_group_segment_fixed_size 0
  .amdhsa_kernarg_size 80
  .amdhsa_user_sgpr_count 2
  .amdhsa_user_sgpr_kernarg_segment_ptr 1
  .amdhsa_system_sgpr_workgroup_id_x 1
.end_amdhsa_kernel
```
